```python
import torch

def _softmax(x, axis=-1):
    return torch.softmax(x, dim=axis)
def _gelu(x):
    return torch.nn.functional.gelu(x, approximate="tanh")
def _silu(x):
    return torch.nn.functional.silu(x)
def _sigmoid(x):
    return torch.sigmoid(x)
def _layernorm(x, axis=-1, eps=1e-5):
    m = x.mean(dim=axis, keepdim=True)
    v = x.var(dim=axis, keepdim=True, unbiased=False)
    return (x - m) / torch.sqrt(v + eps)
def _scatter_add(tgt, idx, src, axis=0):
    return tgt.clone().index_add_(axis, idx, src)
def _segment_sum(src, seg, n):
    out = torch.zeros((n,) + src.shape[1:], dtype=src.dtype)
    return out.index_add_(0, seg, src)
def _pad(x, pw):
    flat = tuple(v for pair in reversed(pw) for v in pair)
    return torch.nn.functional.pad(x, flat)

kernel_name = 'recurrent_scan__mha_block__moe_arch_mod__prompt'

def setup_inputs():

    _w = (lambda a: (lambda t: t.to(torch.bfloat16) if t.is_floating_point() else t)(torch.as_tensor(a)))
    def _A_setup():
        B, S, D, H = 1, 2048, 448, 16
        return {
            "x": _w((lambda *s: torch.randn(*s, dtype=torch.bfloat16) * 0.05)(B, S, D)),
            "wqkv": _w((lambda *s: torch.randn(*s, dtype=torch.bfloat16) * 0.05)(D, 3 * D)),
            "wo": _w((lambda *s: torch.randn(*s, dtype=torch.bfloat16) * 0.05)(D, D)),
        }
    _A_in = _A_setup()

    def _B_setup():
        B, S, D, F, C = 1, 2048, 448, 1792, 2
        return {
            "x": _w((lambda *s: torch.randn(*s, dtype=torch.bfloat16) * 0.05)(B, S, D)),
            "w_r": _w((lambda *s: torch.randn(*s, dtype=torch.bfloat16) * 0.05)(D)),
            "w_gate": _w((lambda *s: torch.randn(*s, dtype=torch.bfloat16) * 0.05)(D, F)),
            "w_up": _w((lambda *s: torch.randn(*s, dtype=torch.bfloat16) * 0.05)(D, F)),
            "w_down": _w((lambda *s: torch.randn(*s, dtype=torch.bfloat16) * 0.05)(F, D)),
        }
    _B_in = _B_setup()

    return {
        "A_x": _A_in["x"],
        "A_wqkv": _A_in["wqkv"],
        "A_wo": _A_in["wo"],
        "B_x": _B_in["x"],
        "B_w_r": _B_in["w_r"],
        "B_w_gate": _B_in["w_gate"],
        "B_w_up": _B_in["w_up"],
        "B_w_down": _B_in["w_down"],
    }

def reference(A_x, A_wqkv, A_wo, B_x, B_w_r, B_w_gate, B_w_up, B_w_down):
    def _A_ref(x, wqkv, wo):
        B, S, D = x.shape
        H = 16
        Dh = D // H
        qkv = (lambda x, *d: x.permute(*d))((x @ wqkv).reshape(B, S, 3, H, Dh), 2, 0, 3, 1, 4)
        q, k, v = qkv[0], qkv[1], qkv[2]
        scores = torch.einsum("bhqd,bhkd->bhqk", q, k) * (Dh ** -0.5)
        p = _softmax(scores, axis=-1)
        o = torch.einsum("bhqk,bhkd->bhqd", p, v)
        return (lambda x, *d: x.permute(*d))(o, 0, 2, 1, 3).reshape(B, S, D) @ wo

    def _B_ref(x, w_r, w_gate, w_up, w_down):
        B, S, D = x.shape
        C = 2
        r = x @ w_r
        idx = torch.argsort(-r, axis=-1)[:, :C]
        idx_e = (lambda x, n, axis: torch.repeat_interleave(x, n, dim=axis))(idx.reshape(B, C, 1), D, axis=2)
        x_sel = (lambda x, i, axis: torch.take_along_dim(x, i, dim=axis))(x, idx_e, axis=1)
        g = _silu(x_sel @ w_gate)
        u = x_sel @ w_up
        y = (g * u) @ w_down
        r_sel = _sigmoid((lambda x, i, axis: torch.take_along_dim(x, i, dim=axis))(r, idx, axis=1))
        y = y * r_sel.reshape(B, C, 1)
        b_off = (torch.arange(B) * S).reshape(B, 1)
        flat_idx = (idx + b_off).reshape(B * C)
        zero = (x * 0.0).reshape(B * S, D)
        upd = _scatter_add(zero, flat_idx, y.reshape(B * C, D), axis=0)
        return x + upd.reshape(B, S, D)

    x = A_x
    xn = _layernorm(x, axis=-1)
    s = _A_ref(xn, A_wqkv, A_wo)
    g = _silu(_B_ref(xn, B_w_r, B_w_gate, B_w_up, B_w_down))
    return x + s * g
```

```asm
; @launch grid=(256,1,1) block=(512,1,1) lds=163840
.amdgcn_target "amdgcn-amd-amdhsa--gfx950"
.text
.globl recurrent_scan__mha_block__moe_arch_mod__prompt_kernel
.p2align 8
.type recurrent_scan__mha_block__moe_arch_mod__prompt_kernel,@function
recurrent_scan__mha_block__moe_arch_mod__prompt_kernel:
    s_cmp_ge_u32 s2, 0x100
    s_cbranch_scc1 L_END
    s_load_dwordx2 s[4:5], s[0:1], 0
    s_load_dwordx2 s[8:9], s[0:1], 8
    s_load_dwordx2 s[12:13], s[0:1], 80
    s_load_dwordx2 s[32:33], s[0:1], 32
    s_getpc_b64 s[56:57]
L_PC:
    v_lshrrev_b32 v1, 6, v0
    s_and_b32 s41, s2, 0xf8
    v_lshrrev_b32 v2, 5, v0
    v_readfirstlane_b32 s40, v1
    v_lshl_add_u32 v2, s41, 1, v2
    v_lshlrev_b32 v2, 7, v2
    v_min_u32 v2, L_END-L_PC, v2
    global_load_dword v1, v2, s[56:57]
    v_and_b32 v4, 31, v0
    v_bfe_u32 v5, v0, 5, 1
    v_and_b32 v0, 63, v0
    s_bfe_u32 s43, s2, 0x20003
    s_bfe_u32 s38, s2, 0x20000
    s_lshl_b32 s38, s38, 2
    s_add_u32 s38, s38, s43
    s_lshr_b32 s44, s2, 5
    s_bfe_u32 s39, s2, 0x10002
    s_lshl_b32 s39, s39, 3
    s_add_u32 s39, s39, s44
    s_mov_b32 s6, 0x1c0000
    s_mov_b32 s7, 0x20000
    s_lshr_b32 s47, s40, 1
    s_and_b32 s48, s40, 1
    s_cmp_ge_u32 s40, 4
    s_cbranch_scc1 L_LATE
    s_lshl_b32 s41, s38, 4
    s_add_u32 s41, s41, s39
    s_lshl_b32 s41, s41, 2
    s_add_u32 s46, s41, s40
    s_mul_i32 s42, s46, 1792
    v_cmp_gt_u32 vcc, 28, v4
    v_lshlrev_b32 v126, 4, v4
    v_bfrev_b32 v84, 2
    v_cndmask_b32 v84, v84, v126, vcc
    v_mul_u32_u24 v85, 896, v5
    v_add_u32 v85, v85, v84
    s_mov_b32 s34, 0x380
    s_mov_b32 s35, 0x20000
    s_waitcnt lgkmcnt(0)
    buffer_load_dwordx4 v[96:99], v85, s[4:7], s42 offen offset:0
    buffer_load_dwordx4 v[100:103], v85, s[4:7], s42 offen offset:448
    buffer_load_dwordx4 v[104:107], v84, s[32:35], 0 offen offset:0
    buffer_load_dwordx4 v[108:111], v84, s[32:35], 0 offen offset:448
    s_load_dword s36, s[12:13], 0
    s_lshr_b32 s41, s2, 3
    s_mul_i32 s41, s41, 294
    s_sub_u32 s42, s39, s44
    s_mul_i32 s42, s42, 7
    s_lshr_b32 s42, s42, 4
    s_add_u32 s41, s41, s42
    s_add_u32 s41, s41, s40
    v_min_u32 v84, 13, v4
    v_mad_u32_u24 v84, v84, 21, s41
    v_lshlrev_b32 v84, 7, v84
    global_load_dword v1, v84, s[8:9]
    s_branch L_EARLY
L_LATE:
    s_mul_i32 s43, s43, 2
    s_mul_i32 s44, s44, 1
    s_add_u32 s45, s43, s44
    s_mul_i32 s41, s45, 37
    s_lshr_b32 s41, s41, 8
    s_mul_i32 s41, s41, 7
    s_sub_u32 s45, s45, s41
    s_lshl_b32 s64, s45, 7
    s_and_b32 s43, s40, 3
    v_lshrrev_b32 v84, 3, v0
    v_and_b32 v85, 7, v0
    v_lshrrev_b32 v86, 4, v0
    v_lshl_or_b32 v87, s48, 2, v86
    v_xor_b32 v87, v87, v85
    v_mul_u32_u24 v15, 56, v84
    v_add_lshl_u32 v15, v15, v87, 4
    v_and_b32 v86, 1, v86
    v_lshlrev_b32 v86, 2, v86
    v_xor_b32 v86, v86, v85
    v_mul_u32_u24 v14, 168, v84
    v_add_lshl_u32 v14, v14, v86, 4
    s_mul_i32 s42, s43, 168
    s_add_u32 s42, s42, s39
    s_add_u32 s42, s42, 7
    s_lshl_b32 s49, s42, 7
    s_lshl_b32 s41, s38, 4
    s_add_u32 s41, s41, s43
    s_mul_i32 s50, s41, 7168
    s_lshl_b32 s51, s43, 10
    s_mov_b32 s10, 0x126000
    s_mov_b32 s11, 0x20000
    s_cmp_ge_u32 s39, 14
    s_waitcnt lgkmcnt(0)
    s_cbranch_scc1 L_LATE_L
    s_mul_i32 s41, s64, 1344
    s_add_u32 m0, s51, 0
    s_add_u32 s41, s41, s49
    buffer_load_dwordx4 v14, s[8:11], s41 offen lds
    s_add_u32 m0, s51, 4096
    s_add_u32 s41, s41, 86016
    buffer_load_dwordx4 v14, s[8:11], s41 offen lds
    s_add_u32 m0, s51, 98304
    s_add_u32 s41, s50, s64
    buffer_load_dwordx4 v15, s[4:7], s41 offen lds
    s_add_u32 m0, s51, 102400
    s_add_u32 s41, s41, 28672
    buffer_load_dwordx4 v15, s[4:7], s41 offen lds
    s_add_u32 s41, s64, 128
    s_cmp_lt_u32 s41, 896
    s_cselect_b32 s65, s41, 0
    s_mul_i32 s41, s65, 1344
    s_add_u32 m0, s51, 8192
    s_add_u32 s41, s41, s49
    buffer_load_dwordx4 v14, s[8:11], s41 offen lds
    s_add_u32 m0, s51, 12288
    s_add_u32 s41, s41, 86016
    buffer_load_dwordx4 v14, s[8:11], s41 offen lds
    s_add_u32 m0, s51, 57344
    s_add_u32 s41, s50, s64
    s_add_u32 s41, s41, 57344
    buffer_load_dwordx4 v15, s[4:7], s41 offen lds
    s_add_u32 m0, s51, 61440
    s_add_u32 s41, s41, 28672
    buffer_load_dwordx4 v15, s[4:7], s41 offen lds
    s_load_dwordx2 s[16:17], s[0:1], 16
    s_load_dwordx2 s[28:29], s[0:1], 56
    s_load_dwordx2 s[24:25], s[0:1], 40
    s_load_dwordx2 s[60:61], s[0:1], 48
    s_mov_b32 s14, 0x800000
    s_mov_b32 s15, 0x20000
    s_mov_b32 s18, 0x62000
    s_mov_b32 s19, 0x20000
    s_mov_b32 s30, 0x188000
    s_mov_b32 s31, 0x20000
    s_mov_b32 s26, 0x188000
    s_mov_b32 s27, 0x20000
    s_mov_b32 s52, 0x0fffffff
    s_mov_b32 s53, 0x0fffffff
    s_mov_b32 s54, -1
    s_mov_b32 s55, 0
    s_mov_b32 s72, -1
    s_mov_b32 s73, 0x00ffffff
    v_lshlrev_b32 v3, 3, v0
    v_lshlrev_b32 v6, 4, v0
    v_mov_b32 v2, 0xdddddddd
    v_lshlrev_b32 v126, 4, v4
    v_bfe_u32 v84, v4, 1, 3
    v_xor_b32 v84, v84, v5
    v_lshlrev_b32 v84, 4, v84
    v_lshl_add_u32 v8, v4, 7, v84
    v_bfe_u32 v84, v0, 2, 2
    v_lshl_add_u32 v85, v5, 3, v84
    v_lshrrev_b32 v86, 1, v84
    v_xor_b32 v86, s48, v86
    v_lshlrev_b32 v86, 6, v86
    v_lshl_add_u32 v86, v85, 7, v86
    v_and_b32 v87, 16, v0
    v_bfrev_b32 v88, v0
    v_lshrrev_b32 v88, 30, v88
    v_and_b32 v89, 3, v0
    s_cmp_lt_u32 s39, 7
    s_cselect_b64 vcc, -1, 0
    v_lshlrev_b32 v87, 1, v87
    v_cndmask_b32 v89, v89, v88, vcc
    v_lshl_add_u32 v89, v89, 3, v87
    v_add_u32 v12, v89, v86
    v_lshl_add_u32 v88, v88, 3, v87
    v_lshl_add_u32 v88, v85, 6, v88
    v_add_u32 v13, 114688, v88
    s_lshl_b32 s44, s38, 2
    s_add_u32 s41, s44, s47
    s_mov_b32 s74, s41
    s_lshl_b32 s71, s41, 9
    s_add_u32 s71, s71, 32768
    s_lshl_b32 s41, s41, 11
    s_add_u32 s75, s41, 65536
    s_lshl_b32 s41, s48, 1
    s_add_u32 s63, s47, s41
    s_lshl_b32 s41, s48, 10
    s_add_u32 s3, s71, s41
    s_lshl_b32 s41, s48, 7
    s_add_u32 s41, s41, 155648
    v_lshl_add_u32 v127, v4, 2, s41
    s_lshl_b32 s41, s40, 7
    s_add_u32 s41, s41, 156672
    v_lshl_add_u32 v249, v4, 2, s41
    v_lshl_add_u32 v250, v5, 4, s41
    s_lshl_b32 s41, s63, 11
    s_add_u32 s41, s41, 143360
    v_add_u32 v251, s41, v6
    v_add_u32 v252, 156160, v126
    v_mov_b32 v78, 0
    v_mov_b32 v79, 0
    s_add_u32 s41, s40, 1
    s_and_b32 s41, s41, 3
    s_lshl_b32 s41, s41, 11
    s_add_u32 s41, s41, 143360
    v_add_u32 v244, s41, v6
    v_mov_b32 v240, 0
    s_add_u32 s41, s40, 2
    s_and_b32 s41, s41, 3
    s_lshl_b32 s41, s41, 11
    s_add_u32 s41, s41, 143360
    v_add_u32 v245, s41, v6
    v_mov_b32 v241, 0
    s_add_u32 s41, s40, 3
    s_and_b32 s41, s41, 3
    s_lshl_b32 s41, s41, 11
    s_add_u32 s41, s41, 143360
    v_add_u32 v246, s41, v6
    v_mov_b32 v242, 0
    s_add_u32 s41, s40, 4
    s_and_b32 s41, s41, 3
    s_lshl_b32 s41, s41, 11
    s_add_u32 s41, s41, 143360
    v_add_u32 v247, s41, v6
    v_mov_b32 v243, 0
    s_lshl2_add_u32 s43, s47, s48
    s_lshl4_add_u32 s41, s43, s39
    s_lshl_b32 s41, s41, 7
    s_add_u32 s41, s41, 65536
    s_add_u32 s76, s12, s41
    s_addc_u32 s77, s13, 0
    s_lshl_b32 s41, s39, 6
    s_add_u32 s41, s41, s43
    s_lshl_b32 s41, s41, 11
    s_add_u32 s98, s41, 3145728
    s_mul_i32 s41, s39, 7
    s_lshr_b32 s41, s41, 1
    s_mul_i32 s42, s43, 56
    s_add_u32 s41, s41, s42
    s_lshl_b32 s41, s41, 9
    s_add_u32 s59, s41, 1048576
    s_movk_i32 s41, 0x3f80
    v_writelane_b32 v240, s41, 31
    v_cmp_eq_u32 vcc, 28, v4
    v_mov_b32 v84, 0x3f803f80
    v_mul_u32_u24 v85, 74, v0
    v_cndmask_b32 v248, 0, v84, vcc
    v_lshrrev_b32 v85, 10, v85
    v_mul_u32_u24 v85, 672, v85
    v_add_u32 v253, v85, v6
    s_and_b32 s41, s39, 3
    s_mul_i32 s41, s41, 224
    s_mul_i32 s42, s40, 50176
    s_add_u32 s99, s41, s42
    s_mul_i32 s78, s40, 12544
    s_lshr_b32 s41, s39, 2
    s_lshl_b32 s41, s41, 2
    s_add_u32 s41, s41, s38
    s_mul_i32 s42, s41, 37
    s_lshr_b32 s42, s42, 8
    s_mul_i32 s42, s42, 7
    s_sub_u32 s41, s41, s42
    s_mul_i32 s79, s41, 1792
    s_and_b32 s41, s2, 7
    s_mul_i32 s41, s41, 14
    s_lshr_b32 s42, s2, 4
    s_add_u32 s62, s41, s42
    s_lshl1_add_u32 s41, s39, s48
    s_cmp_ge_u32 s39, 7
    s_cselect_b32 s42, 14, 0
    s_cselect_b32 s43, 8, 0
    s_sub_u32 s41, s41, s42
    s_cmp_ge_u32 s41, 7
    s_cselect_b32 s42, 7, 0
    s_addc_u32 s44, s41, 0
    s_sub_u32 s41, s41, s42
    s_lshl_b32 s44, s44, 7
    s_add_u32 s43, s43, s44
    s_cmp_ge_u32 s39, 14
    s_cselect_b32 s43, 0x40000000, s43
    s_cmp_eq_u32 s41, 0
    s_cselect_b32 s42, 0, 4
    s_cmp_eq_u32 s41, 6
    s_cselect_b32 s42, 132, s42
    v_mov_b32 v251, 4
    s_movk_i32 s41, 128
    v_writelane_b32 v251, s41, 1
    v_writelane_b32 v251, s42, 2
    v_add_u32 v251, s43, v251
    v_lshrrev_b32 v120, 2, v0
    v_xor_b32 v120, v120, v0
    v_and_b32 v120, 4, v120
    v_cmp_eq_u32 vcc, 0, v120
    v_mov_b32 v121, 0x3f803f80
    s_nop 0
    v_cndmask_b32 v120, 0, v121, vcc
    v_mov_b32 v121, v120
    v_mov_b32 v122, v120
    v_mov_b32 v123, v120
    v_add_u32 v125, s51, v13
    s_lshr_b32 s41, s51, 8
    v_add_u32 v80, s41, v252
    v_lshrrev_b32 v84, 2, v0
    v_and_b32 v85, 48, v6
    v_mul_u32_u24 v7, 2688, v84
    v_add_u32 v7, v7, v85
    s_mul_i32 s42, s51, 42
    s_mul_i32 s41, s39, 56
    s_andn2_b32 s41, s41, 15
    s_add_u32 s45, s41, s42
    s_waitcnt lgkmcnt(0)
    s_min_u32 s62, s62, 111
    s_cmp_ge_u32 s62, 56
    s_cselect_b32 s24, s60, s24
    s_cselect_b32 s25, s61, s25
    s_cselect_b32 s41, 56, 0
    s_sub_u32 s41, s62, s41
    s_cmp_ge_u32 s41, 28
    s_cselect_b32 s42, 799232, 0
    s_lshl_b32 s41, s41, 7
    s_add_u32 s41, s41, s42
    s_and_b32 s43, s2, 8
    s_lshl_b32 s43, s43, 3
    s_add_u32 s100, s41, s43
    s_mul_i32 s41, s62, 9363
    s_lshr_b32 s41, s41, 16
    s_mul_i32 s41, s41, 99456
    s_lshl_b32 s42, s62, 7
    s_add_u32 s41, s41, s42
    s_add_u32 s101, s41, s43
    s_lshl_b32 s41, s47, 12
    s_add_u32 s41, s41, 49152
    v_mov_b32 v77, 0
    v_add_u32 v8, s41, v8
    v_xor_b32 v9, 32, v8
    v_xor_b32 v10, 64, v8
    v_xor_b32 v11, 96, v8
    s_add_u32 m0, s51, 106496
    s_add_u32 s41, s50, s65
    buffer_load_dwordx4 v15, s[4:7], s41 offen lds
    s_add_u32 m0, s51, 110592
    s_add_u32 s41, s41, 28672
    buffer_load_dwordx4 v15, s[4:7], s41 offen lds
    s_waitcnt vmcnt(8)
    s_add_u32 s41, s65, 128
    s_cmp_lt_u32 s41, 896
    s_cselect_b32 s66, s41, 0
    s_mul_i32 s41, s66, 1344
    s_add_u32 m0, s51, 16384
    s_add_u32 s41, s41, s49
    buffer_load_dwordx4 v14, s[8:11], s41 offen lds
    s_add_u32 m0, s51, 20480
    s_add_u32 s41, s41, 86016
    buffer_load_dwordx4 v14, s[8:11], s41 offen lds
    s_waitcnt vmcnt(8)
    s_add_u32 m0, s51, 114688
    s_add_u32 s41, s50, s66
    buffer_load_dwordx4 v15, s[4:7], s41 offen lds
    s_add_u32 m0, s51, 118784
    s_add_u32 s41, s41, 28672
    buffer_load_dwordx4 v15, s[4:7], s41 offen lds
    s_barrier
    v_mov_b32 v84, 157696
    ds_read_b32 v84, v84
    s_waitcnt lgkmcnt(0)
    v_readfirstlane_b32 s36, v84
    s_waitcnt vmcnt(8)
    s_add_u32 s41, s66, 128
    s_cmp_lt_u32 s41, 896
    s_cselect_b32 s67, s41, 0
    s_mul_i32 s41, s67, 1344
    s_add_u32 m0, s51, 24576
    s_add_u32 s41, s41, s49
    buffer_load_dwordx4 v14, s[8:11], s41 offen lds
    s_add_u32 m0, s51, 28672
    s_add_u32 s41, s41, 86016
    buffer_load_dwordx4 v14, s[8:11], s41 offen lds
    s_waitcnt vmcnt(8)
    s_add_u32 m0, s51, 122880
    s_add_u32 s41, s50, s67
    buffer_load_dwordx4 v15, s[4:7], s41 offen lds
    s_add_u32 m0, s51, 126976
    s_add_u32 s41, s41, 28672
    buffer_load_dwordx4 v15, s[4:7], s41 offen lds
    ds_read_b64_tr_b16 v[128:129], v12 offset:0
    ds_read_b64_tr_b16 v[130:131], v12 offset:512
    ds_read_b64_tr_b16 v[132:133], v12 offset:2048
    ds_read_b64_tr_b16 v[134:135], v12 offset:2560
    ds_read_b64_tr_b16 v[136:137], v12 offset:4096
    ds_read_b64_tr_b16 v[138:139], v12 offset:4608
    ds_read_b64_tr_b16 v[140:141], v12 offset:6144
    ds_read_b64_tr_b16 v[142:143], v12 offset:6656
    s_waitcnt vmcnt(8)
    s_add_u32 s41, s67, 128
    s_cmp_lt_u32 s41, 896
    s_cselect_b32 s68, s41, 0
    s_mul_i32 s41, s68, 1344
    s_add_u32 m0, s51, 32768
    s_add_u32 s41, s41, s49
    buffer_load_dwordx4 v14, s[8:11], s41 offen lds
    s_add_u32 m0, s51, 36864
    s_add_u32 s41, s41, 86016
    buffer_load_dwordx4 v14, s[8:11], s41 offen lds
    s_barrier
    s_waitcnt vmcnt(8)
    s_add_u32 m0, s51, 131072
    s_add_u32 s41, s50, s68
    buffer_load_dwordx4 v15, s[4:7], s41 offen lds
    s_add_u32 m0, s51, 135168
    s_add_u32 s41, s41, 28672
    buffer_load_dwordx4 v15, s[4:7], s41 offen lds
    ds_read_b64_tr_b16 v[144:145], v12 offset:8192
    ds_read_b64_tr_b16 v[146:147], v12 offset:8704
    ds_read_b64_tr_b16 v[148:149], v12 offset:10240
    ds_read_b64_tr_b16 v[150:151], v12 offset:10752
    ds_read_b64_tr_b16 v[152:153], v12 offset:12288
    ds_read_b64_tr_b16 v[154:155], v12 offset:12800
    ds_read_b64_tr_b16 v[156:157], v12 offset:14336
    ds_read_b64_tr_b16 v[158:159], v12 offset:14848
    s_waitcnt vmcnt(8)
    s_add_u32 s41, s68, 128
    s_cmp_lt_u32 s41, 896
    s_cselect_b32 s69, s41, 0
    s_mul_i32 s41, s69, 1344
    s_add_u32 m0, s51, 40960
    s_add_u32 s41, s41, s49
    buffer_load_dwordx4 v14, s[8:11], s41 offen lds
    s_add_u32 m0, s51, 45056
    s_add_u32 s41, s41, 86016
    buffer_load_dwordx4 v14, s[8:11], s41 offen lds
    s_barrier
    s_waitcnt vmcnt(8)
    s_add_u32 m0, s51, 139264
    s_add_u32 s41, s50, s69
    buffer_load_dwordx4 v15, s[4:7], s41 offen lds
    s_add_u32 m0, s51, 143360
    s_add_u32 s41, s41, 28672
    buffer_load_dwordx4 v15, s[4:7], s41 offen lds
    ds_read_b64_tr_b16 v[160:161], v12 offset:16384
    ds_read_b64_tr_b16 v[162:163], v12 offset:16896
    ds_read_b64_tr_b16 v[164:165], v12 offset:18432
    ds_read_b64_tr_b16 v[166:167], v12 offset:18944
    ds_read_b64_tr_b16 v[168:169], v12 offset:20480
    ds_read_b64_tr_b16 v[170:171], v12 offset:20992
    ds_read_b64_tr_b16 v[172:173], v12 offset:22528
    ds_read_b64_tr_b16 v[174:175], v12 offset:23040
    s_waitcnt vmcnt(8)
    s_add_u32 s41, s69, 128
    s_cmp_lt_u32 s41, 896
    s_cselect_b32 s70, s41, 0
    s_mul_i32 s41, s70, 1344
    s_add_u32 m0, s51, 49152
    s_add_u32 s41, s41, s49
    buffer_load_dwordx4 v14, s[8:11], s41 offen lds
    s_add_u32 m0, s51, 53248
    s_add_u32 s41, s41, 86016
    buffer_load_dwordx4 v14, s[8:11], s41 offen lds
    s_barrier
    s_waitcnt vmcnt(8)
    s_add_u32 m0, s51, 147456
    s_add_u32 s41, s50, s70
    buffer_load_dwordx4 v15, s[4:7], s41 offen lds
    s_add_u32 m0, s51, 151552
    s_add_u32 s41, s41, 28672
    buffer_load_dwordx4 v15, s[4:7], s41 offen lds
    ds_read_b64_tr_b16 v[176:177], v12 offset:24576
    ds_read_b64_tr_b16 v[178:179], v12 offset:25088
    ds_read_b64_tr_b16 v[180:181], v12 offset:26624
    ds_read_b64_tr_b16 v[182:183], v12 offset:27136
    ds_read_b64_tr_b16 v[184:185], v12 offset:28672
    ds_read_b64_tr_b16 v[186:187], v12 offset:29184
    ds_read_b64_tr_b16 v[188:189], v12 offset:30720
    ds_read_b64_tr_b16 v[190:191], v12 offset:31232
    s_waitcnt vmcnt(8)
    s_add_u32 m0, s51, 65536
    s_add_u32 s41, s50, s65
    s_add_u32 s41, s41, 57344
    buffer_load_dwordx4 v15, s[4:7], s41 offen lds
    s_add_u32 m0, s51, 69632
    s_add_u32 s41, s41, 28672
    buffer_load_dwordx4 v15, s[4:7], s41 offen lds
    s_barrier
    s_waitcnt vmcnt(8)
    s_add_u32 m0, s51, 73728
    s_add_u32 s41, s50, s66
    s_add_u32 s41, s41, 57344
    buffer_load_dwordx4 v15, s[4:7], s41 offen lds
    s_add_u32 m0, s51, 77824
    s_add_u32 s41, s41, 28672
    buffer_load_dwordx4 v15, s[4:7], s41 offen lds
    ds_read_b64_tr_b16 v[192:193], v12 offset:32768
    ds_read_b64_tr_b16 v[194:195], v12 offset:33280
    ds_read_b64_tr_b16 v[196:197], v12 offset:34816
    ds_read_b64_tr_b16 v[198:199], v12 offset:35328
    ds_read_b64_tr_b16 v[200:201], v12 offset:36864
    ds_read_b64_tr_b16 v[202:203], v12 offset:37376
    ds_read_b64_tr_b16 v[204:205], v12 offset:38912
    ds_read_b64_tr_b16 v[206:207], v12 offset:39424
    s_waitcnt vmcnt(8)
    s_add_u32 m0, s51, 81920
    s_add_u32 s41, s50, s67
    s_add_u32 s41, s41, 57344
    buffer_load_dwordx4 v15, s[4:7], s41 offen lds
    s_add_u32 m0, s51, 86016
    s_add_u32 s41, s41, 28672
    buffer_load_dwordx4 v15, s[4:7], s41 offen lds
    s_barrier
    s_waitcnt vmcnt(8)
    s_add_u32 m0, s51, 90112
    s_add_u32 s41, s50, s68
    s_add_u32 s41, s41, 57344
    buffer_load_dwordx4 v15, s[4:7], s41 offen lds
    s_add_u32 m0, s51, 94208
    s_add_u32 s41, s41, 28672
    buffer_load_dwordx4 v15, s[4:7], s41 offen lds
    ds_read_b64_tr_b16 v[208:209], v12 offset:40960
    ds_read_b64_tr_b16 v[210:211], v12 offset:41472
    ds_read_b64_tr_b16 v[212:213], v12 offset:43008
    ds_read_b64_tr_b16 v[214:215], v12 offset:43520
    ds_read_b64_tr_b16 v[216:217], v12 offset:45056
    ds_read_b64_tr_b16 v[218:219], v12 offset:45568
    ds_read_b64_tr_b16 v[220:221], v12 offset:47104
    ds_read_b64_tr_b16 v[222:223], v12 offset:47616
    s_waitcnt vmcnt(8)
    s_add_u32 m0, s51, 98304
    s_add_u32 s41, s50, s69
    s_add_u32 s41, s41, 57344
    buffer_load_dwordx4 v15, s[4:7], s41 offen lds
    s_add_u32 m0, s51, 102400
    s_add_u32 s41, s41, 28672
    buffer_load_dwordx4 v15, s[4:7], s41 offen lds
    s_barrier
    s_waitcnt vmcnt(8)
    s_add_u32 m0, s51, 106496
    s_add_u32 s41, s50, s70
    s_add_u32 s41, s41, 57344
    buffer_load_dwordx4 v15, s[4:7], s41 offen lds
    s_add_u32 m0, s51, 110592
    s_add_u32 s41, s41, 28672
    buffer_load_dwordx4 v15, s[4:7], s41 offen lds
    buffer_load_dwordx4 v[64:67], v126, s[12:15], s71 offen sc1
    ds_read_b64_tr_b16 v[224:225], v12 offset:49152
    ds_read_b64_tr_b16 v[226:227], v12 offset:49664
    ds_read_b64_tr_b16 v[228:229], v12 offset:51200
    ds_read_b64_tr_b16 v[230:231], v12 offset:51712
    ds_read_b64_tr_b16 v[232:233], v12 offset:53248
    ds_read_b64_tr_b16 v[234:235], v12 offset:53760
    ds_read_b64_tr_b16 v[236:237], v12 offset:55296
    ds_read_b64_tr_b16 v[238:239], v12 offset:55808
    s_waitcnt vmcnt(9)
    s_mul_i32 s41, s64, 1344
    s_add_u32 m0, s51, 114688
    s_add_u32 s41, s41, s45
    buffer_load_dwordx4 v7, s[8:11], s41 offen lds
    s_waitcnt vmcnt(8)
    s_mul_i32 s41, s65, 1344
    s_add_u32 m0, s51, 118784
    s_add_u32 s41, s41, s45
    buffer_load_dwordx4 v7, s[8:11], s41 offen lds
    s_waitcnt vmcnt(7)
    s_mul_i32 s41, s66, 1344
    s_add_u32 m0, s51, 122880
    s_add_u32 s41, s41, s45
    buffer_load_dwordx4 v7, s[8:11], s41 offen lds
    s_waitcnt vmcnt(6)
    s_mul_i32 s41, s67, 1344
    s_add_u32 m0, s51, 126976
    s_add_u32 s41, s41, s45
    buffer_load_dwordx4 v7, s[8:11], s41 offen lds
    s_waitcnt vmcnt(5)
    s_mul_i32 s41, s68, 1344
    s_add_u32 m0, s51, 131072
    s_add_u32 s41, s41, s45
    buffer_load_dwordx4 v7, s[8:11], s41 offen lds
    s_cmp_ge_u32 s39, 7
    s_cbranch_scc1 L_LATE_V
    s_setprio 1
    s_waitcnt lgkmcnt(0)
    s_barrier
    ds_read_b128 v[32:35], v8 offset:0
    ds_read_b128 v[36:39], v9 offset:0
    ds_read_b128 v[40:43], v10 offset:0
    ds_read_b128 v[44:47], v11 offset:0
    ds_read_b128 v[48:51], v8 offset:8192
    ds_read_b128 v[52:55], v9 offset:8192
    s_waitcnt lgkmcnt(5)
    v_mfma_f32_32x32x16_bf16 v[16:31], v[128:131], v[32:35], 0
    ds_read_b128 v[56:59], v10 offset:8192
    s_mul_i32 s41, s69, 1344
    s_add_u32 m0, s51, 135168
    s_add_u32 s41, s41, s45
    buffer_load_dwordx4 v7, s[8:11], s41 offen lds
    s_waitcnt lgkmcnt(5)
    v_mfma_f32_32x32x16_bf16 v[16:31], v[132:135], v[36:39], v[16:31]
    ds_read_b128 v[60:63], v11 offset:8192
    s_waitcnt lgkmcnt(5)
    v_mfma_f32_32x32x16_bf16 v[16:31], v[136:139], v[40:43], v[16:31]
    ds_read_b128 v[32:35], v8 offset:16384
    s_mul_i32 s41, s70, 1344
    s_add_u32 m0, s51, 139264
    s_add_u32 s41, s41, s45
    buffer_load_dwordx4 v7, s[8:11], s41 offen lds
    s_waitcnt lgkmcnt(5)
    v_mfma_f32_32x32x16_bf16 v[16:31], v[140:143], v[44:47], v[16:31]
    ds_read_b128 v[36:39], v9 offset:16384
    s_mul_i32 s74, s74, 28672
    s_lshl1_add_u32 s43, s39, s48
    s_waitcnt lgkmcnt(5)
    v_mfma_f32_32x32x16_bf16 v[16:31], v[144:147], v[48:51], v[16:31]
    ds_read_b128 v[40:43], v10 offset:16384
    s_lshl_b32 s43, s43, 11
    s_add_u32 s74, s74, s43
    s_waitcnt lgkmcnt(5)
    v_mfma_f32_32x32x16_bf16 v[16:31], v[148:151], v[52:55], v[16:31]
    ds_read_b128 v[44:47], v11 offset:16384
    s_add_u32 s74, s74, 1048576
    v_and_b32 v84, 0x33, v0
    s_waitcnt lgkmcnt(5)
    v_mfma_f32_32x32x16_bf16 v[16:31], v[152:155], v[56:59], v[16:31]
    ds_read_b128 v[48:51], v8 offset:24576
    v_bfe_u32 v85, v0, 2, 1
    v_lshl_or_b32 v84, v85, 3, v84
    s_waitcnt lgkmcnt(5)
    v_mfma_f32_32x32x16_bf16 v[16:31], v[156:159], v[60:63], v[16:31]
    ds_read_b128 v[52:55], v9 offset:24576
    v_bfe_u32 v85, v0, 3, 1
    v_lshl_or_b32 v84, v85, 2, v84
    s_waitcnt lgkmcnt(5)
    v_mfma_f32_32x32x16_bf16 v[16:31], v[160:163], v[32:35], v[16:31]
    ds_read_b128 v[56:59], v10 offset:24576
    v_lshlrev_b32 v124, 4, v84
    s_waitcnt lgkmcnt(5)
    v_mfma_f32_32x32x16_bf16 v[16:31], v[164:167], v[36:39], v[16:31]
    ds_read_b128 v[60:63], v11 offset:24576
    s_waitcnt lgkmcnt(5)
    v_mfma_f32_32x32x16_bf16 v[16:31], v[168:171], v[40:43], v[16:31]
    ds_read_b128 v[32:35], v8 offset:32768
    s_waitcnt lgkmcnt(5)
    v_mfma_f32_32x32x16_bf16 v[16:31], v[172:175], v[44:47], v[16:31]
    ds_read_b128 v[36:39], v9 offset:32768
    s_waitcnt lgkmcnt(5)
    v_mfma_f32_32x32x16_bf16 v[16:31], v[176:179], v[48:51], v[16:31]
    ds_read_b128 v[40:43], v10 offset:32768
    s_waitcnt lgkmcnt(5)
    v_mfma_f32_32x32x16_bf16 v[16:31], v[180:183], v[52:55], v[16:31]
    ds_read_b128 v[44:47], v11 offset:32768
    s_waitcnt lgkmcnt(5)
    v_mfma_f32_32x32x16_bf16 v[16:31], v[184:187], v[56:59], v[16:31]
    ds_read_b128 v[48:51], v8 offset:40960
    s_waitcnt lgkmcnt(5)
    v_mfma_f32_32x32x16_bf16 v[16:31], v[188:191], v[60:63], v[16:31]
    ds_read_b128 v[52:55], v9 offset:40960
    s_waitcnt lgkmcnt(5)
    v_mfma_f32_32x32x16_bf16 v[16:31], v[192:195], v[32:35], v[16:31]
    ds_read_b128 v[56:59], v10 offset:40960
    s_waitcnt lgkmcnt(5)
    v_mfma_f32_32x32x16_bf16 v[16:31], v[196:199], v[36:39], v[16:31]
    ds_read_b128 v[60:63], v11 offset:40960
    s_waitcnt lgkmcnt(5)
    v_mfma_f32_32x32x16_bf16 v[16:31], v[200:203], v[40:43], v[16:31]
    ds_read_b128 v[32:35], v8 offset:49152
    s_waitcnt lgkmcnt(5)
    v_mfma_f32_32x32x16_bf16 v[16:31], v[204:207], v[44:47], v[16:31]
    ds_read_b128 v[36:39], v9 offset:49152
    s_waitcnt lgkmcnt(5)
    v_mfma_f32_32x32x16_bf16 v[16:31], v[208:211], v[48:51], v[16:31]
    ds_read_b128 v[40:43], v10 offset:49152
    s_waitcnt lgkmcnt(5)
    v_mfma_f32_32x32x16_bf16 v[16:31], v[212:215], v[52:55], v[16:31]
    ds_read_b128 v[44:47], v11 offset:49152
    ds_read_b32 v76, v127
    s_waitcnt lgkmcnt(6)
    v_mfma_f32_32x32x16_bf16 v[16:31], v[216:219], v[56:59], v[16:31]
    s_waitcnt lgkmcnt(5)
    v_mfma_f32_32x32x16_bf16 v[16:31], v[220:223], v[60:63], v[16:31]
    s_waitcnt lgkmcnt(0)
    v_mfma_f32_32x32x16_bf16 v[16:31], v[224:227], v[32:35], v[16:31]
    s_waitcnt vmcnt(7)
    v_cmp_ne_u32 vcc, s36, v67
    s_cbranch_vccnz RETRY_1
OK_3:
    v_xor_b32 v72, 0x80000000, v64
    v_cndmask_b32 v72, 0, v72, s[54:55]
    v_lshrrev_b32 v73, 16, v72
    v_mfma_f32_32x32x16_bf16 v[16:31], v[228:231], v[36:39], v[16:31]
    v_or_b32 v74, v72, v73
    v_or_b32 v75, v72, v73
    v_or_b32 v73, v72, v73
    v_mov_b32 v72, v74
    v_mfma_f32_32x32x16_bf16 v[16:31], v[232:235], v[40:43], v[16:31]
    v_mov_b32 v64, v65
    v_mfma_f32_32x32x16_bf16 v[16:31], v[236:239], v[44:47], v[16:31]
    v_mfma_f32_32x32x16_bf16 v[16:31], v[76:79], v[72:75], v[16:31]
    s_waitcnt vmcnt(3) lgkmcnt(0)
    s_barrier
    s_nop 9
    v_mul_f32 v16, v16, v64
    v_mul_f32 v17, v17, v64
    v_cvt_pk_bf16_f32 v104, v16, v17
    v_mul_f32 v18, v18, v64
    v_mul_f32 v19, v19, v64
    v_cvt_pk_bf16_f32 v105, v18, v19
    v_mul_f32 v20, v20, v64
    v_mul_f32 v21, v21, v64
    v_cvt_pk_bf16_f32 v106, v20, v21
    v_mul_f32 v22, v22, v64
    v_mul_f32 v23, v23, v64
    v_cvt_pk_bf16_f32 v107, v22, v23
    buffer_store_dwordx4 v[104:107], v124, s[12:15], s74 offen offset:0 sc1
    v_mul_f32 v24, v24, v64
    v_mul_f32 v25, v25, v64
    v_cvt_pk_bf16_f32 v108, v24, v25
    v_mul_f32 v26, v26, v64
    v_mul_f32 v27, v27, v64
    v_cvt_pk_bf16_f32 v109, v26, v27
    v_mul_f32 v28, v28, v64
    v_mul_f32 v29, v29, v64
    v_cvt_pk_bf16_f32 v110, v28, v29
    v_mul_f32 v30, v30, v64
    v_mul_f32 v31, v31, v64
    v_cvt_pk_bf16_f32 v111, v30, v31
    buffer_store_dwordx4 v[108:111], v124, s[12:15], s74 offen offset:1024 sc1
    s_waitcnt vmcnt(2)
    s_branch L_LJOIN
L_LATE_L:
    s_add_u32 m0, s51, 57344
    s_add_u32 s41, s50, s64
    s_add_u32 s41, s41, 57344
    buffer_load_dwordx4 v15, s[4:7], s41 offen lds
    s_add_u32 m0, s51, 61440
    s_add_u32 s41, s41, 28672
    buffer_load_dwordx4 v15, s[4:7], s41 offen lds
    s_add_u32 m0, s51, 0
    s_add_u32 s41, s50, s64
    buffer_load_dwordx4 v15, s[4:7], s41 offen lds
    s_add_u32 m0, s51, 4096
    s_add_u32 s41, s41, 28672
    buffer_load_dwordx4 v15, s[4:7], s41 offen lds
    s_add_u32 s41, s64, 128
    s_cmp_lt_u32 s41, 896
    s_cselect_b32 s65, s41, 0
    s_add_u32 m0, s51, 65536
    s_add_u32 s41, s50, s65
    s_add_u32 s41, s41, 57344
    buffer_load_dwordx4 v15, s[4:7], s41 offen lds
    s_add_u32 m0, s51, 69632
    s_add_u32 s41, s41, 28672
    buffer_load_dwordx4 v15, s[4:7], s41 offen lds
    s_add_u32 m0, s51, 8192
    s_add_u32 s41, s50, s65
    buffer_load_dwordx4 v15, s[4:7], s41 offen lds
    s_add_u32 m0, s51, 12288
    s_add_u32 s41, s41, 28672
    buffer_load_dwordx4 v15, s[4:7], s41 offen lds
    s_add_u32 s41, s65, 128
    s_cmp_lt_u32 s41, 896
    s_cselect_b32 s66, s41, 0
    s_add_u32 m0, s51, 73728
    s_add_u32 s41, s50, s66
    s_add_u32 s41, s41, 57344
    buffer_load_dwordx4 v15, s[4:7], s41 offen lds
    s_add_u32 m0, s51, 77824
    s_add_u32 s41, s41, 28672
    buffer_load_dwordx4 v15, s[4:7], s41 offen lds
    s_add_u32 m0, s51, 16384
    s_add_u32 s41, s50, s66
    buffer_load_dwordx4 v15, s[4:7], s41 offen lds
    s_add_u32 m0, s51, 20480
    s_add_u32 s41, s41, 28672
    buffer_load_dwordx4 v15, s[4:7], s41 offen lds
    s_load_dwordx2 s[16:17], s[0:1], 16
    s_load_dwordx2 s[28:29], s[0:1], 56
    s_load_dwordx2 s[24:25], s[0:1], 40
    s_load_dwordx2 s[60:61], s[0:1], 48
    s_mov_b32 s14, 0x800000
    s_mov_b32 s15, 0x20000
    s_mov_b32 s18, 0x62000
    s_mov_b32 s19, 0x20000
    s_mov_b32 s30, 0x188000
    s_mov_b32 s31, 0x20000
    s_mov_b32 s26, 0x188000
    s_mov_b32 s27, 0x20000
    s_mov_b32 s52, 0x0fffffff
    s_mov_b32 s53, 0x0fffffff
    s_mov_b32 s54, -1
    s_mov_b32 s55, 0
    s_mov_b32 s72, -1
    s_mov_b32 s73, 0x00ffffff
    v_lshlrev_b32 v3, 3, v0
    v_lshlrev_b32 v6, 4, v0
    v_mov_b32 v2, 0xdddddddd
    v_lshlrev_b32 v126, 4, v4
    v_bfe_u32 v84, v4, 1, 3
    v_xor_b32 v84, v84, v5
    v_lshlrev_b32 v84, 4, v84
    v_lshl_add_u32 v8, v4, 7, v84
    v_bfe_u32 v84, v0, 2, 2
    v_lshl_add_u32 v85, v5, 3, v84
    v_lshrrev_b32 v86, 1, v84
    v_xor_b32 v86, s48, v86
    v_lshlrev_b32 v86, 6, v86
    v_lshl_add_u32 v86, v85, 7, v86
    v_and_b32 v87, 16, v0
    v_bfrev_b32 v88, v0
    v_lshrrev_b32 v88, 30, v88
    v_and_b32 v89, 3, v0
    s_cmp_lt_u32 s39, 7
    s_cselect_b64 vcc, -1, 0
    v_lshlrev_b32 v87, 1, v87
    v_cndmask_b32 v89, v89, v88, vcc
    v_lshl_add_u32 v89, v89, 3, v87
    v_add_u32 v12, v89, v86
    v_lshl_add_u32 v88, v88, 3, v87
    v_lshl_add_u32 v88, v85, 6, v88
    v_add_u32 v13, 114688, v88
    s_lshl_b32 s44, s38, 2
    s_add_u32 s41, s44, s47
    s_mov_b32 s74, s41
    s_lshl_b32 s71, s41, 9
    s_add_u32 s71, s71, 32768
    s_lshl_b32 s41, s41, 11
    s_add_u32 s75, s41, 65536
    s_lshl_b32 s41, s48, 1
    s_add_u32 s63, s47, s41
    s_lshl_b32 s41, s48, 10
    s_add_u32 s3, s71, s41
    s_lshl_b32 s41, s48, 7
    s_add_u32 s41, s41, 155648
    v_lshl_add_u32 v127, v4, 2, s41
    s_lshl_b32 s41, s40, 7
    s_add_u32 s41, s41, 156672
    v_lshl_add_u32 v249, v4, 2, s41
    v_lshl_add_u32 v250, v5, 4, s41
    s_lshl_b32 s41, s63, 11
    s_add_u32 s41, s41, 143360
    v_add_u32 v251, s41, v6
    v_add_u32 v252, 156160, v126
    v_mov_b32 v78, 0
    v_mov_b32 v79, 0
    s_add_u32 s41, s40, 1
    s_and_b32 s41, s41, 3
    s_lshl_b32 s41, s41, 11
    s_add_u32 s41, s41, 143360
    v_add_u32 v244, s41, v6
    v_mov_b32 v240, 0
    s_add_u32 s41, s40, 2
    s_and_b32 s41, s41, 3
    s_lshl_b32 s41, s41, 11
    s_add_u32 s41, s41, 143360
    v_add_u32 v245, s41, v6
    v_mov_b32 v241, 0
    s_add_u32 s41, s40, 3
    s_and_b32 s41, s41, 3
    s_lshl_b32 s41, s41, 11
    s_add_u32 s41, s41, 143360
    v_add_u32 v246, s41, v6
    v_mov_b32 v242, 0
    s_add_u32 s41, s40, 4
    s_and_b32 s41, s41, 3
    s_lshl_b32 s41, s41, 11
    s_add_u32 s41, s41, 143360
    v_add_u32 v247, s41, v6
    v_mov_b32 v243, 0
    s_lshl2_add_u32 s43, s47, s48
    s_lshl4_add_u32 s41, s43, s39
    s_lshl_b32 s41, s41, 7
    s_add_u32 s41, s41, 65536
    s_add_u32 s76, s12, s41
    s_addc_u32 s77, s13, 0
    s_lshl_b32 s41, s39, 6
    s_add_u32 s41, s41, s43
    s_lshl_b32 s41, s41, 11
    s_add_u32 s98, s41, 3145728
    s_mul_i32 s41, s39, 7
    s_lshr_b32 s41, s41, 1
    s_mul_i32 s42, s43, 56
    s_add_u32 s41, s41, s42
    s_lshl_b32 s41, s41, 9
    s_add_u32 s59, s41, 1048576
    s_movk_i32 s41, 0x3f80
    v_writelane_b32 v240, s41, 31
    v_cmp_eq_u32 vcc, 28, v4
    v_mov_b32 v84, 0x3f803f80
    v_mul_u32_u24 v85, 74, v0
    v_cndmask_b32 v248, 0, v84, vcc
    v_lshrrev_b32 v85, 10, v85
    v_mul_u32_u24 v85, 672, v85
    v_add_u32 v253, v85, v6
    s_and_b32 s41, s39, 3
    s_mul_i32 s41, s41, 224
    s_mul_i32 s42, s40, 50176
    s_add_u32 s99, s41, s42
    s_mul_i32 s78, s40, 12544
    s_lshr_b32 s41, s39, 2
    s_lshl_b32 s41, s41, 2
    s_add_u32 s41, s41, s38
    s_mul_i32 s42, s41, 37
    s_lshr_b32 s42, s42, 8
    s_mul_i32 s42, s42, 7
    s_sub_u32 s41, s41, s42
    s_mul_i32 s79, s41, 1792
    s_and_b32 s41, s2, 7
    s_mul_i32 s41, s41, 14
    s_lshr_b32 s42, s2, 4
    s_add_u32 s62, s41, s42
    s_lshl1_add_u32 s41, s39, s48
    s_cmp_ge_u32 s39, 7
    s_cselect_b32 s42, 14, 0
    s_cselect_b32 s43, 8, 0
    s_sub_u32 s41, s41, s42
    s_cmp_ge_u32 s41, 7
    s_cselect_b32 s42, 7, 0
    s_addc_u32 s44, s41, 0
    s_sub_u32 s41, s41, s42
    s_lshl_b32 s44, s44, 7
    s_add_u32 s43, s43, s44
    s_cmp_ge_u32 s39, 14
    s_cselect_b32 s43, 0x40000000, s43
    s_cmp_eq_u32 s41, 0
    s_cselect_b32 s42, 0, 4
    s_cmp_eq_u32 s41, 6
    s_cselect_b32 s42, 132, s42
    v_mov_b32 v251, 4
    s_movk_i32 s41, 128
    v_writelane_b32 v251, s41, 1
    v_writelane_b32 v251, s42, 2
    v_add_u32 v251, s43, v251
    v_lshrrev_b32 v120, 2, v0
    v_xor_b32 v120, v120, v0
    v_and_b32 v120, 4, v120
    v_cmp_eq_u32 vcc, 0, v120
    v_mov_b32 v121, 0x3f803f80
    s_nop 0
    v_cndmask_b32 v120, 0, v121, vcc
    v_mov_b32 v121, v120
    v_mov_b32 v122, v120
    v_mov_b32 v123, v120
    v_add_u32 v125, s51, v13
    s_lshr_b32 s41, s51, 8
    v_add_u32 v80, s41, v252
    v_lshrrev_b32 v84, 2, v0
    v_and_b32 v85, 48, v6
    v_mul_u32_u24 v7, 2688, v84
    v_add_u32 v7, v7, v85
    s_mul_i32 s42, s51, 42
    s_mul_i32 s41, s39, 56
    s_andn2_b32 s41, s41, 15
    s_add_u32 s45, s41, s42
    s_waitcnt lgkmcnt(0)
    s_min_u32 s62, s62, 111
    s_cmp_ge_u32 s62, 56
    s_cselect_b32 s24, s60, s24
    s_cselect_b32 s25, s61, s25
    s_cselect_b32 s41, 56, 0
    s_sub_u32 s41, s62, s41
    s_cmp_ge_u32 s41, 28
    s_cselect_b32 s42, 799232, 0
    s_lshl_b32 s41, s41, 7
    s_add_u32 s41, s41, s42
    s_and_b32 s43, s2, 8
    s_lshl_b32 s43, s43, 3
    s_add_u32 s100, s41, s43
    s_mul_i32 s41, s62, 9363
    s_lshr_b32 s41, s41, 16
    s_mul_i32 s41, s41, 99456
    s_lshl_b32 s42, s62, 7
    s_add_u32 s41, s41, s42
    s_add_u32 s101, s41, s43
    s_add_u32 s41, s66, 128
    s_cmp_lt_u32 s41, 896
    s_cselect_b32 s67, s41, 0
    s_add_u32 m0, s51, 81920
    s_add_u32 s41, s50, s67
    s_add_u32 s41, s41, 57344
    buffer_load_dwordx4 v15, s[4:7], s41 offen lds
    s_add_u32 m0, s51, 86016
    s_add_u32 s41, s41, 28672
    buffer_load_dwordx4 v15, s[4:7], s41 offen lds
    s_add_u32 m0, s51, 24576
    s_add_u32 s41, s50, s67
    buffer_load_dwordx4 v15, s[4:7], s41 offen lds
    s_add_u32 m0, s51, 28672
    s_add_u32 s41, s41, 28672
    buffer_load_dwordx4 v15, s[4:7], s41 offen lds
    s_add_u32 s41, s67, 128
    s_cmp_lt_u32 s41, 896
    s_cselect_b32 s68, s41, 0
    s_add_u32 m0, s51, 90112
    s_add_u32 s41, s50, s68
    s_add_u32 s41, s41, 57344
    buffer_load_dwordx4 v15, s[4:7], s41 offen lds
    s_add_u32 m0, s51, 94208
    s_add_u32 s41, s41, 28672
    buffer_load_dwordx4 v15, s[4:7], s41 offen lds
    s_add_u32 m0, s51, 32768
    s_add_u32 s41, s50, s68
    buffer_load_dwordx4 v15, s[4:7], s41 offen lds
    s_add_u32 m0, s51, 36864
    s_add_u32 s41, s41, 28672
    buffer_load_dwordx4 v15, s[4:7], s41 offen lds
    s_add_u32 s41, s68, 128
    s_cmp_lt_u32 s41, 896
    s_cselect_b32 s69, s41, 0
    s_add_u32 m0, s51, 98304
    s_add_u32 s41, s50, s69
    s_add_u32 s41, s41, 57344
    buffer_load_dwordx4 v15, s[4:7], s41 offen lds
    s_add_u32 m0, s51, 102400
    s_add_u32 s41, s41, 28672
    buffer_load_dwordx4 v15, s[4:7], s41 offen lds
    s_add_u32 m0, s51, 40960
    s_add_u32 s41, s50, s69
    buffer_load_dwordx4 v15, s[4:7], s41 offen lds
    s_add_u32 m0, s51, 45056
    s_add_u32 s41, s41, 28672
    buffer_load_dwordx4 v15, s[4:7], s41 offen lds
    s_add_u32 s41, s69, 128
    s_cmp_lt_u32 s41, 896
    s_cselect_b32 s70, s41, 0
    s_add_u32 m0, s51, 106496
    s_add_u32 s41, s50, s70
    s_add_u32 s41, s41, 57344
    buffer_load_dwordx4 v15, s[4:7], s41 offen lds
    s_add_u32 m0, s51, 110592
    s_add_u32 s41, s41, 28672
    buffer_load_dwordx4 v15, s[4:7], s41 offen lds
    s_add_u32 m0, s51, 49152
    s_add_u32 s41, s50, s70
    buffer_load_dwordx4 v15, s[4:7], s41 offen lds
    s_add_u32 m0, s51, 53248
    s_add_u32 s41, s41, 28672
    buffer_load_dwordx4 v15, s[4:7], s41 offen lds
    s_mul_i32 s41, s64, 1344
    s_add_u32 m0, s51, 114688
    s_add_u32 s41, s41, s45
    buffer_load_dwordx4 v7, s[8:11], s41 offen lds
    s_mul_i32 s41, s65, 1344
    s_add_u32 m0, s51, 118784
    s_add_u32 s41, s41, s45
    buffer_load_dwordx4 v7, s[8:11], s41 offen lds
    s_mul_i32 s41, s66, 1344
    s_add_u32 m0, s51, 122880
    s_add_u32 s41, s41, s45
    buffer_load_dwordx4 v7, s[8:11], s41 offen lds
    s_mul_i32 s41, s67, 1344
    s_add_u32 m0, s51, 126976
    s_add_u32 s41, s41, s45
    buffer_load_dwordx4 v7, s[8:11], s41 offen lds
    s_mul_i32 s41, s68, 1344
    s_add_u32 m0, s51, 131072
    s_add_u32 s41, s41, s45
    buffer_load_dwordx4 v7, s[8:11], s41 offen lds
    s_mul_i32 s41, s69, 1344
    s_add_u32 m0, s51, 135168
    s_add_u32 s41, s41, s45
    buffer_load_dwordx4 v7, s[8:11], s41 offen lds
    s_mul_i32 s41, s70, 1344
    s_add_u32 m0, s51, 139264
    s_add_u32 s41, s41, s45
    buffer_load_dwordx4 v7, s[8:11], s41 offen lds
    s_waitcnt vmcnt(7)
    s_barrier
    v_mov_b32 v84, 157696
    ds_read_b32 v84, v84
    s_waitcnt lgkmcnt(0)
    v_readfirstlane_b32 s36, v84
    s_waitcnt vmcnt(3)
    s_barrier
    s_waitcnt vmcnt(0)
    s_lshl_b32 s41, s40, 8
    s_add_u32 s41, s41, s2
    s_cmp_eq_u32 s41, 1279
    s_cbranch_scc1 SIDE_4
BACK_5:
    s_branch L_LJOIN
L_EARLY_L:
    s_mul_i32 s41, s48, 57344
    s_lshl_b32 s42, s47, 12
    s_add_u32 s41, s41, s42
    v_add_u32 v8, s41, v8
    v_xor_b32 v9, 32, v8
    v_xor_b32 v10, 64, v8
    v_xor_b32 v11, 96, v8
    v_mov_b32 v120, 0x3f803f80
    v_mov_b32 v112, 0
    v_mov_b32 v113, 0
    v_mov_b32 v114, 0
    v_mov_b32 v115, 0
    v_lshlrev_b32 v85, 4, v5
    v_mov_b32 v86, 157696
    v_lshlrev_b32 v87, 2, v4
    v_add_u32 v87, 157760, v87
    s_waitcnt lgkmcnt(0)
    s_mul_i32 s36, s36, 0x9e3779b1
    s_add_u32 s36, s36, 0x7f4a7c15
    v_mov_b32 v119, s36
    ds_write_b32 v86, v119
    ds_write_b32 v87, v112
    s_min_u32 s62, s62, 111
    s_cmp_ge_u32 s62, 56
    s_cselect_b32 s24, s60, s24
    s_cselect_b32 s25, s61, s25
    s_cselect_b32 s41, 56, 0
    s_sub_u32 s41, s62, s41
    s_cmp_ge_u32 s41, 28
    s_cselect_b32 s42, 799232, 0
    s_lshl_b32 s41, s41, 7
    s_add_u32 s41, s41, s42
    s_and_b32 s43, s2, 8
    s_lshl_b32 s43, s43, 3
    s_add_u32 s100, s41, s43
    s_mul_i32 s41, s62, 9363
    s_lshr_b32 s41, s41, 16
    s_mul_i32 s41, s41, 99456
    s_lshl_b32 s42, s62, 7
    s_add_u32 s41, s41, s42
    s_add_u32 s101, s41, s43
    s_lshl2_add_u32 s41, s38, s40
    s_lshl4_add_u32 s41, s41, s39
    s_lshl_b32 s41, s41, 7
    s_add_u32 s41, s41, 65536
    v_mul_u32_u24 v84, 262144, v5
    buffer_load_dword v255, v84, s[12:15], s41 offen sc1
    s_lshl_b32 s42, s46, 5
    s_add_u32 s42, s42, 32768
    s_waitcnt vmcnt(2)
    v_dot2c_f32_bf16 v112, v96, v120
    v_dot2c_f32_bf16 v113, v96, v96
    v_dot2c_f32_bf16 v114, v96, v104
    v_dot2c_f32_bf16 v115, v104, v120
    v_dot2c_f32_bf16 v112, v97, v120
    v_dot2c_f32_bf16 v113, v97, v97
    v_dot2c_f32_bf16 v114, v97, v105
    v_dot2c_f32_bf16 v115, v105, v120
    v_dot2c_f32_bf16 v112, v98, v120
    v_dot2c_f32_bf16 v113, v98, v98
    v_dot2c_f32_bf16 v114, v98, v106
    v_dot2c_f32_bf16 v115, v106, v120
    v_dot2c_f32_bf16 v112, v99, v120
    v_dot2c_f32_bf16 v113, v99, v99
    v_dot2c_f32_bf16 v114, v99, v107
    v_dot2c_f32_bf16 v115, v107, v120
    v_dot2c_f32_bf16 v112, v100, v120
    v_dot2c_f32_bf16 v113, v100, v100
    v_dot2c_f32_bf16 v114, v100, v108
    v_dot2c_f32_bf16 v115, v108, v120
    v_dot2c_f32_bf16 v112, v101, v120
    v_dot2c_f32_bf16 v113, v101, v101
    v_dot2c_f32_bf16 v114, v101, v109
    v_dot2c_f32_bf16 v115, v109, v120
    v_dot2c_f32_bf16 v112, v102, v120
    v_dot2c_f32_bf16 v113, v102, v102
    v_dot2c_f32_bf16 v114, v102, v110
    v_dot2c_f32_bf16 v115, v110, v120
    v_dot2c_f32_bf16 v112, v103, v120
    v_dot2c_f32_bf16 v113, v103, v103
    v_dot2c_f32_bf16 v114, v103, v111
    v_dot2c_f32_bf16 v115, v111, v120
    v_add_f32_dpp v112, v112, v112 row_shr:1 row_mask:0xf bank_mask:0xf
    v_add_f32_dpp v113, v113, v113 row_shr:1 row_mask:0xf bank_mask:0xf
    v_add_f32_dpp v114, v114, v114 row_shr:1 row_mask:0xf bank_mask:0xf
    v_add_f32_dpp v115, v115, v115 row_shr:1 row_mask:0xf bank_mask:0xf
    v_add_f32_dpp v112, v112, v112 row_shr:2 row_mask:0xf bank_mask:0xf
    v_add_f32_dpp v113, v113, v113 row_shr:2 row_mask:0xf bank_mask:0xf
    v_add_f32_dpp v114, v114, v114 row_shr:2 row_mask:0xf bank_mask:0xf
    v_add_f32_dpp v115, v115, v115 row_shr:2 row_mask:0xf bank_mask:0xf
    v_add_f32_dpp v112, v112, v112 row_shr:4 row_mask:0xf bank_mask:0xf
    v_add_f32_dpp v113, v113, v113 row_shr:4 row_mask:0xf bank_mask:0xf
    v_add_f32_dpp v114, v114, v114 row_shr:4 row_mask:0xf bank_mask:0xf
    v_add_f32_dpp v115, v115, v115 row_shr:4 row_mask:0xf bank_mask:0xf
    v_add_f32_dpp v112, v112, v112 row_shr:8 row_mask:0xf bank_mask:0xf
    v_add_f32_dpp v113, v113, v113 row_shr:8 row_mask:0xf bank_mask:0xf
    v_add_f32_dpp v114, v114, v114 row_shr:8 row_mask:0xf bank_mask:0xf
    v_add_f32_dpp v115, v115, v115 row_shr:8 row_mask:0xf bank_mask:0xf
    v_add_f32_dpp v112, v112, v112 row_bcast:15 row_mask:0xa bank_mask:0xf
    v_add_f32_dpp v113, v113, v113 row_bcast:15 row_mask:0xa bank_mask:0xf
    v_add_f32_dpp v114, v114, v114 row_bcast:15 row_mask:0xa bank_mask:0xf
    v_add_f32_dpp v115, v115, v115 row_bcast:15 row_mask:0xa bank_mask:0xf
    v_mul_f32 v112, 0x3b124925, v112
    v_mul_f32 v113, 0x3b124925, v113
    v_fma_f32 v113, -v112, v112, v113
    v_max_f32 v113, 0, v113
    v_cvt_pk_bf16_f32 v84, v112, v113
    v_lshlrev_b32 v116, 16, v84
    v_and_b32 v84, 0xffff0000, v84
    v_add_f32 v84, 0x3727c5ac, v84
    v_cvt_pk_bf16_f32 v84, v84, v84
    v_and_b32 v84, 0xffff0000, v84
    v_sqrt_f32 v84, v84
    v_fma_f32 v114, -v116, v115, v114
    v_cvt_pk_bf16_f32 v84, v84, v84
    v_and_b32 v84, 0xffff0000, v84
    v_rcp_f32 v117, v84
    s_mov_b32 exec_lo, 0x80000000
    s_mov_b32 exec_hi, 0x80000000
    v_mul_f32 v118, v114, v117
    buffer_store_dwordx4 v[116:119], v85, s[12:15], s42 offen sc1
    s_mov_b64 exec, -1
    s_cmp_eq_u32 s2, 255
    s_cbranch_scc1 SIDE_6
BACK_7:
    buffer_load_dwordx4 v[68:71], v126, s[12:15], s3 offen sc1
    s_waitcnt lgkmcnt(0)
    s_barrier
    ds_read_b128 v[128:131], v8 offset:0
    ds_read_b128 v[132:135], v9 offset:0
    ds_read_b128 v[136:139], v10 offset:0
    ds_read_b128 v[140:143], v11 offset:0
    ds_read_b128 v[144:147], v8 offset:8192
    ds_read_b128 v[148:151], v9 offset:8192
    ds_read_b128 v[152:155], v10 offset:8192
    ds_read_b128 v[156:159], v11 offset:8192
    ds_read_b128 v[160:163], v8 offset:16384
    ds_read_b128 v[164:167], v9 offset:16384
    ds_read_b128 v[168:171], v10 offset:16384
    ds_read_b128 v[172:175], v11 offset:16384
    ds_read_b128 v[176:179], v8 offset:24576
    ds_read_b128 v[180:183], v9 offset:24576
    ds_read_b128 v[184:187], v10 offset:24576
    ds_read_b128 v[188:191], v11 offset:24576
    ds_read_b128 v[192:195], v8 offset:32768
    ds_read_b128 v[196:199], v9 offset:32768
    ds_read_b128 v[200:203], v10 offset:32768
    ds_read_b128 v[204:207], v11 offset:32768
    ds_read_b128 v[208:211], v8 offset:40960
    ds_read_b128 v[212:215], v9 offset:40960
    ds_read_b128 v[216:219], v10 offset:40960
    ds_read_b128 v[220:223], v11 offset:40960
    ds_read_b128 v[224:227], v8 offset:49152
    ds_read_b128 v[228:231], v9 offset:49152
    ds_read_b128 v[232:235], v10 offset:49152
    ds_read_b128 v[236:239], v11 offset:49152
    s_waitcnt vmcnt(0)
    s_branch L_QEARLY
L_EARLY:
    s_load_dwordx2 s[16:17], s[0:1], 16
    s_load_dwordx2 s[28:29], s[0:1], 56
    s_load_dwordx2 s[24:25], s[0:1], 40
    s_load_dwordx2 s[60:61], s[0:1], 48
    s_mov_b32 s14, 0x800000
    s_mov_b32 s15, 0x20000
    s_mov_b32 s18, 0x62000
    s_mov_b32 s19, 0x20000
    s_mov_b32 s30, 0x188000
    s_mov_b32 s31, 0x20000
    s_mov_b32 s26, 0x188000
    s_mov_b32 s27, 0x20000
    s_mov_b32 s52, 0x0fffffff
    s_mov_b32 s53, 0x0fffffff
    s_mov_b32 s54, -1
    s_mov_b32 s55, 0
    s_mov_b32 s72, -1
    s_mov_b32 s73, 0x00ffffff
    v_lshlrev_b32 v3, 3, v0
    v_lshlrev_b32 v6, 4, v0
    v_mov_b32 v2, 0xdddddddd
    v_lshlrev_b32 v126, 4, v4
    v_bfe_u32 v84, v4, 1, 3
    v_xor_b32 v84, v84, v5
    v_lshlrev_b32 v84, 4, v84
    v_lshl_add_u32 v8, v4, 7, v84
    v_bfe_u32 v84, v0, 2, 2
    v_lshl_add_u32 v85, v5, 3, v84
    v_lshrrev_b32 v86, 1, v84
    v_xor_b32 v86, s48, v86
    v_lshlrev_b32 v86, 6, v86
    v_lshl_add_u32 v86, v85, 7, v86
    v_and_b32 v87, 16, v0
    v_bfrev_b32 v88, v0
    v_lshrrev_b32 v88, 30, v88
    v_and_b32 v89, 3, v0
    s_cmp_lt_u32 s39, 7
    s_cselect_b64 vcc, -1, 0
    v_lshlrev_b32 v87, 1, v87
    v_cndmask_b32 v89, v89, v88, vcc
    v_lshl_add_u32 v89, v89, 3, v87
    v_add_u32 v12, v89, v86
    v_lshl_add_u32 v88, v88, 3, v87
    v_lshl_add_u32 v88, v85, 6, v88
    v_add_u32 v13, 114688, v88
    s_lshl_b32 s44, s38, 2
    s_add_u32 s41, s44, s47
    s_mov_b32 s74, s41
    s_lshl_b32 s71, s41, 9
    s_add_u32 s71, s71, 32768
    s_lshl_b32 s41, s41, 11
    s_add_u32 s75, s41, 65536
    s_lshl_b32 s41, s48, 1
    s_add_u32 s63, s47, s41
    s_lshl_b32 s41, s48, 10
    s_add_u32 s3, s71, s41
    s_lshl_b32 s41, s48, 7
    s_add_u32 s41, s41, 155648
    v_lshl_add_u32 v127, v4, 2, s41
    s_lshl_b32 s41, s40, 7
    s_add_u32 s41, s41, 156672
    v_lshl_add_u32 v249, v4, 2, s41
    v_lshl_add_u32 v250, v5, 4, s41
    s_lshl_b32 s41, s63, 11
    s_add_u32 s41, s41, 143360
    v_add_u32 v251, s41, v6
    v_add_u32 v252, 156160, v126
    v_mov_b32 v78, 0
    v_mov_b32 v79, 0
    s_add_u32 s41, s40, 1
    s_and_b32 s41, s41, 3
    s_lshl_b32 s41, s41, 11
    s_add_u32 s41, s41, 143360
    v_add_u32 v244, s41, v6
    v_mov_b32 v240, 0
    s_add_u32 s41, s40, 2
    s_and_b32 s41, s41, 3
    s_lshl_b32 s41, s41, 11
    s_add_u32 s41, s41, 143360
    v_add_u32 v245, s41, v6
    v_mov_b32 v241, 0
    s_add_u32 s41, s40, 3
    s_and_b32 s41, s41, 3
    s_lshl_b32 s41, s41, 11
    s_add_u32 s41, s41, 143360
    v_add_u32 v246, s41, v6
    v_mov_b32 v242, 0
    s_add_u32 s41, s40, 4
    s_and_b32 s41, s41, 3
    s_lshl_b32 s41, s41, 11
    s_add_u32 s41, s41, 143360
    v_add_u32 v247, s41, v6
    v_mov_b32 v243, 0
    s_lshl2_add_u32 s43, s47, s48
    s_lshl4_add_u32 s41, s43, s39
    s_lshl_b32 s41, s41, 7
    s_add_u32 s41, s41, 65536
    s_add_u32 s76, s12, s41
    s_addc_u32 s77, s13, 0
    s_lshl_b32 s41, s39, 6
    s_add_u32 s41, s41, s43
    s_lshl_b32 s41, s41, 11
    s_add_u32 s98, s41, 3145728
    s_mul_i32 s41, s39, 7
    s_lshr_b32 s41, s41, 1
    s_mul_i32 s42, s43, 56
    s_add_u32 s41, s41, s42
    s_lshl_b32 s41, s41, 9
    s_add_u32 s59, s41, 1048576
    s_movk_i32 s41, 0x3f80
    v_writelane_b32 v240, s41, 31
    v_cmp_eq_u32 vcc, 28, v4
    v_mov_b32 v84, 0x3f803f80
    v_mul_u32_u24 v85, 74, v0
    v_cndmask_b32 v248, 0, v84, vcc
    v_lshrrev_b32 v85, 10, v85
    v_mul_u32_u24 v85, 672, v85
    v_add_u32 v253, v85, v6
    s_and_b32 s41, s39, 3
    s_mul_i32 s41, s41, 224
    s_mul_i32 s42, s40, 50176
    s_add_u32 s99, s41, s42
    s_mul_i32 s78, s40, 12544
    s_lshr_b32 s41, s39, 2
    s_lshl_b32 s41, s41, 2
    s_add_u32 s41, s41, s38
    s_mul_i32 s42, s41, 37
    s_lshr_b32 s42, s42, 8
    s_mul_i32 s42, s42, 7
    s_sub_u32 s41, s41, s42
    s_mul_i32 s79, s41, 1792
    s_and_b32 s41, s2, 7
    s_mul_i32 s41, s41, 14
    s_lshr_b32 s42, s2, 4
    s_add_u32 s62, s41, s42
    s_lshl1_add_u32 s41, s39, s48
    s_cmp_ge_u32 s39, 7
    s_cselect_b32 s42, 14, 0
    s_cselect_b32 s43, 8, 0
    s_sub_u32 s41, s41, s42
    s_cmp_ge_u32 s41, 7
    s_cselect_b32 s42, 7, 0
    s_addc_u32 s44, s41, 0
    s_sub_u32 s41, s41, s42
    s_lshl_b32 s44, s44, 7
    s_add_u32 s43, s43, s44
    s_cmp_ge_u32 s39, 14
    s_cselect_b32 s43, 0x40000000, s43
    s_cmp_eq_u32 s41, 0
    s_cselect_b32 s42, 0, 4
    s_cmp_eq_u32 s41, 6
    s_cselect_b32 s42, 132, s42
    v_mov_b32 v14, 4
    s_movk_i32 s41, 128
    v_writelane_b32 v14, s41, 1
    v_writelane_b32 v14, s42, 2
    v_add_u32 v14, s43, v14
    s_cmp_ge_u32 s39, 14
    s_cbranch_scc1 L_EARLY_L
    s_lshl_b32 s41, s47, 12
    s_add_u32 s41, s41, 98304
    v_add_u32 v8, s41, v8
    v_xor_b32 v9, 32, v8
    v_xor_b32 v10, 64, v8
    v_xor_b32 v11, 96, v8
    s_cmp_ge_u32 s39, 7
    s_cbranch_scc1 L_EARLY_V
    s_mul_i32 s74, s74, 28672
    s_lshl1_add_u32 s43, s39, s48
    s_lshl_b32 s43, s43, 11
    s_add_u32 s74, s74, s43
    s_add_u32 s74, s74, 1048576
    v_and_b32 v84, 0x33, v0
    v_bfe_u32 v85, v0, 2, 1
    v_lshl_or_b32 v84, v85, 3, v84
    v_bfe_u32 v85, v0, 3, 1
    v_lshl_or_b32 v84, v85, 2, v84
    v_lshlrev_b32 v124, 4, v84
    v_mov_b32 v120, 0x3f803f80
    v_mov_b32 v112, 0
    v_mov_b32 v113, 0
    v_mov_b32 v114, 0
    v_mov_b32 v115, 0
    v_lshlrev_b32 v85, 4, v5
    v_mov_b32 v86, 157696
    v_lshlrev_b32 v87, 2, v4
    v_add_u32 v87, 157760, v87
    s_waitcnt lgkmcnt(0)
    s_mul_i32 s36, s36, 0x9e3779b1
    s_add_u32 s36, s36, 0x7f4a7c15
    v_mov_b32 v119, s36
    ds_write_b32 v86, v119
    ds_write_b32 v87, v112
    s_min_u32 s62, s62, 111
    s_cmp_ge_u32 s62, 56
    s_cselect_b32 s24, s60, s24
    s_cselect_b32 s25, s61, s25
    s_cselect_b32 s41, 56, 0
    s_sub_u32 s41, s62, s41
    s_cmp_ge_u32 s41, 28
    s_cselect_b32 s42, 799232, 0
    s_lshl_b32 s41, s41, 7
    s_add_u32 s41, s41, s42
    s_and_b32 s43, s2, 8
    s_lshl_b32 s43, s43, 3
    s_add_u32 s100, s41, s43
    s_mul_i32 s41, s62, 9363
    s_lshr_b32 s41, s41, 16
    s_mul_i32 s41, s41, 99456
    s_lshl_b32 s42, s62, 7
    s_add_u32 s41, s41, s42
    s_add_u32 s101, s41, s43
    s_lshl2_add_u32 s41, s38, s40
    s_lshl4_add_u32 s41, s41, s39
    s_lshl_b32 s41, s41, 7
    s_add_u32 s41, s41, 65536
    v_mul_u32_u24 v84, 262144, v5
    buffer_load_dword v255, v84, s[12:15], s41 offen sc1
    s_lshl_b32 s42, s46, 5
    s_add_u32 s42, s42, 32768
    s_waitcnt vmcnt(2)
    v_dot2c_f32_bf16 v112, v96, v120
    v_dot2c_f32_bf16 v113, v96, v96
    v_dot2c_f32_bf16 v114, v96, v104
    v_dot2c_f32_bf16 v115, v104, v120
    v_dot2c_f32_bf16 v112, v97, v120
    v_dot2c_f32_bf16 v113, v97, v97
    v_dot2c_f32_bf16 v114, v97, v105
    v_dot2c_f32_bf16 v115, v105, v120
    v_dot2c_f32_bf16 v112, v98, v120
    v_dot2c_f32_bf16 v113, v98, v98
    v_dot2c_f32_bf16 v114, v98, v106
    v_dot2c_f32_bf16 v115, v106, v120
    v_dot2c_f32_bf16 v112, v99, v120
    v_dot2c_f32_bf16 v113, v99, v99
    v_dot2c_f32_bf16 v114, v99, v107
    v_dot2c_f32_bf16 v115, v107, v120
    v_dot2c_f32_bf16 v112, v100, v120
    v_dot2c_f32_bf16 v113, v100, v100
    v_dot2c_f32_bf16 v114, v100, v108
    v_dot2c_f32_bf16 v115, v108, v120
    v_dot2c_f32_bf16 v112, v101, v120
    v_dot2c_f32_bf16 v113, v101, v101
    v_dot2c_f32_bf16 v114, v101, v109
    v_dot2c_f32_bf16 v115, v109, v120
    v_dot2c_f32_bf16 v112, v102, v120
    v_dot2c_f32_bf16 v113, v102, v102
    v_dot2c_f32_bf16 v114, v102, v110
    v_dot2c_f32_bf16 v115, v110, v120
    v_dot2c_f32_bf16 v112, v103, v120
    v_dot2c_f32_bf16 v113, v103, v103
    v_dot2c_f32_bf16 v114, v103, v111
    v_dot2c_f32_bf16 v115, v111, v120
    v_add_f32_dpp v112, v112, v112 row_shr:1 row_mask:0xf bank_mask:0xf
    v_add_f32_dpp v113, v113, v113 row_shr:1 row_mask:0xf bank_mask:0xf
    v_add_f32_dpp v114, v114, v114 row_shr:1 row_mask:0xf bank_mask:0xf
    v_add_f32_dpp v115, v115, v115 row_shr:1 row_mask:0xf bank_mask:0xf
    v_add_f32_dpp v112, v112, v112 row_shr:2 row_mask:0xf bank_mask:0xf
    v_add_f32_dpp v113, v113, v113 row_shr:2 row_mask:0xf bank_mask:0xf
    v_add_f32_dpp v114, v114, v114 row_shr:2 row_mask:0xf bank_mask:0xf
    v_add_f32_dpp v115, v115, v115 row_shr:2 row_mask:0xf bank_mask:0xf
    v_add_f32_dpp v112, v112, v112 row_shr:4 row_mask:0xf bank_mask:0xf
    v_add_f32_dpp v113, v113, v113 row_shr:4 row_mask:0xf bank_mask:0xf
    v_add_f32_dpp v114, v114, v114 row_shr:4 row_mask:0xf bank_mask:0xf
    v_add_f32_dpp v115, v115, v115 row_shr:4 row_mask:0xf bank_mask:0xf
    v_add_f32_dpp v112, v112, v112 row_shr:8 row_mask:0xf bank_mask:0xf
    v_add_f32_dpp v113, v113, v113 row_shr:8 row_mask:0xf bank_mask:0xf
    v_add_f32_dpp v114, v114, v114 row_shr:8 row_mask:0xf bank_mask:0xf
    v_add_f32_dpp v115, v115, v115 row_shr:8 row_mask:0xf bank_mask:0xf
    v_add_f32_dpp v112, v112, v112 row_bcast:15 row_mask:0xa bank_mask:0xf
    v_add_f32_dpp v113, v113, v113 row_bcast:15 row_mask:0xa bank_mask:0xf
    v_add_f32_dpp v114, v114, v114 row_bcast:15 row_mask:0xa bank_mask:0xf
    v_add_f32_dpp v115, v115, v115 row_bcast:15 row_mask:0xa bank_mask:0xf
    v_mul_f32 v112, 0x3b124925, v112
    v_mul_f32 v113, 0x3b124925, v113
    v_fma_f32 v113, -v112, v112, v113
    v_max_f32 v113, 0, v113
    v_cvt_pk_bf16_f32 v84, v112, v113
    v_lshlrev_b32 v116, 16, v84
    v_and_b32 v84, 0xffff0000, v84
    v_add_f32 v84, 0x3727c5ac, v84
    v_cvt_pk_bf16_f32 v84, v84, v84
    v_and_b32 v84, 0xffff0000, v84
    v_sqrt_f32 v84, v84
    v_fma_f32 v114, -v116, v115, v114
    v_cvt_pk_bf16_f32 v84, v84, v84
    v_and_b32 v84, 0xffff0000, v84
    v_rcp_f32 v117, v84
    s_mov_b32 exec_lo, 0x80000000
    s_mov_b32 exec_hi, 0x80000000
    v_mul_f32 v118, v114, v117
    buffer_store_dwordx4 v[116:119], v85, s[12:15], s42 offen sc1
    s_mov_b64 exec, -1
    v_lshrrev_b32 v120, 2, v0
    v_xor_b32 v120, v120, v0
    v_and_b32 v120, 4, v120
    v_cmp_eq_u32 vcc, 0, v120
    v_mov_b32 v121, 0x3f803f80
    s_nop 0
    v_cndmask_b32 v120, 0, v121, vcc
    v_mov_b32 v121, v120
    v_mov_b32 v122, v120
    v_mov_b32 v123, v120
    v_mov_b32 v77, 0
    s_waitcnt lgkmcnt(0)
    s_barrier
    ds_read_b64_tr_b16 v[32:33], v12 offset:0
    ds_read_b64_tr_b16 v[34:35], v12 offset:512
    ds_read_b128 v[128:131], v8 offset:0
    ds_read_b64_tr_b16 v[36:37], v12 offset:2048
    ds_read_b64_tr_b16 v[38:39], v12 offset:2560
    ds_read_b128 v[132:135], v9 offset:0
    ds_read_b64_tr_b16 v[40:41], v12 offset:4096
    ds_read_b64_tr_b16 v[42:43], v12 offset:4608
    ds_read_b128 v[136:139], v10 offset:0
    ds_read_b64_tr_b16 v[44:45], v12 offset:6144
    ds_read_b64_tr_b16 v[46:47], v12 offset:6656
    ds_read_b128 v[140:143], v11 offset:0
    s_waitcnt lgkmcnt(0)
    s_barrier
    v_mfma_f32_32x32x16_bf16 v[16:31], v[32:35], v[128:131], 0
    ds_read_b64_tr_b16 v[48:49], v12 offset:8192
    ds_read_b64_tr_b16 v[50:51], v12 offset:8704
    ds_read_b128 v[144:147], v8 offset:8192
    v_mfma_f32_16x16x32_bf16 v[112:115], v[120:123], v[32:35], 0
    v_mfma_f32_32x32x16_bf16 v[16:31], v[36:39], v[132:135], v[16:31]
    ds_read_b64_tr_b16 v[52:53], v12 offset:10240
    ds_read_b64_tr_b16 v[54:55], v12 offset:10752
    ds_read_b128 v[148:151], v9 offset:8192
    v_mfma_f32_16x16x32_bf16 v[112:115], v[120:123], v[36:39], v[112:115]
    v_mfma_f32_32x32x16_bf16 v[16:31], v[40:43], v[136:139], v[16:31]
    ds_read_b64_tr_b16 v[56:57], v12 offset:12288
    ds_read_b64_tr_b16 v[58:59], v12 offset:12800
    ds_read_b128 v[152:155], v10 offset:8192
    v_mfma_f32_16x16x32_bf16 v[112:115], v[120:123], v[40:43], v[112:115]
    v_mfma_f32_32x32x16_bf16 v[16:31], v[44:47], v[140:143], v[16:31]
    ds_read_b64_tr_b16 v[60:61], v12 offset:14336
    ds_read_b64_tr_b16 v[62:63], v12 offset:14848
    ds_read_b128 v[156:159], v11 offset:8192
    v_mfma_f32_16x16x32_bf16 v[112:115], v[120:123], v[44:47], v[112:115]
    s_waitcnt lgkmcnt(0)
    s_barrier
    v_mfma_f32_32x32x16_bf16 v[16:31], v[48:51], v[144:147], v[16:31]
    ds_read_b64_tr_b16 v[32:33], v12 offset:16384
    ds_read_b64_tr_b16 v[34:35], v12 offset:16896
    ds_read_b128 v[160:163], v8 offset:16384
    v_mfma_f32_16x16x32_bf16 v[112:115], v[120:123], v[48:51], v[112:115]
    v_mfma_f32_32x32x16_bf16 v[16:31], v[52:55], v[148:151], v[16:31]
    ds_read_b64_tr_b16 v[36:37], v12 offset:18432
    ds_read_b64_tr_b16 v[38:39], v12 offset:18944
    ds_read_b128 v[164:167], v9 offset:16384
    v_mfma_f32_16x16x32_bf16 v[112:115], v[120:123], v[52:55], v[112:115]
    v_mfma_f32_32x32x16_bf16 v[16:31], v[56:59], v[152:155], v[16:31]
    ds_read_b64_tr_b16 v[40:41], v12 offset:20480
    ds_read_b64_tr_b16 v[42:43], v12 offset:20992
    ds_read_b128 v[168:171], v10 offset:16384
    v_mfma_f32_16x16x32_bf16 v[112:115], v[120:123], v[56:59], v[112:115]
    v_mfma_f32_32x32x16_bf16 v[16:31], v[60:63], v[156:159], v[16:31]
    ds_read_b64_tr_b16 v[44:45], v12 offset:22528
    ds_read_b64_tr_b16 v[46:47], v12 offset:23040
    ds_read_b128 v[172:175], v11 offset:16384
    v_mfma_f32_16x16x32_bf16 v[112:115], v[120:123], v[60:63], v[112:115]
    s_waitcnt lgkmcnt(0)
    s_barrier
    v_mfma_f32_32x32x16_bf16 v[16:31], v[32:35], v[160:163], v[16:31]
    ds_read_b64_tr_b16 v[48:49], v12 offset:24576
    ds_read_b64_tr_b16 v[50:51], v12 offset:25088
    ds_read_b128 v[176:179], v8 offset:24576
    v_mfma_f32_16x16x32_bf16 v[112:115], v[120:123], v[32:35], v[112:115]
    v_mfma_f32_32x32x16_bf16 v[16:31], v[36:39], v[164:167], v[16:31]
    ds_read_b64_tr_b16 v[52:53], v12 offset:26624
    ds_read_b64_tr_b16 v[54:55], v12 offset:27136
    ds_read_b128 v[180:183], v9 offset:24576
    v_mfma_f32_16x16x32_bf16 v[112:115], v[120:123], v[36:39], v[112:115]
    v_mfma_f32_32x32x16_bf16 v[16:31], v[40:43], v[168:171], v[16:31]
    ds_read_b64_tr_b16 v[56:57], v12 offset:28672
    ds_read_b64_tr_b16 v[58:59], v12 offset:29184
    ds_read_b128 v[184:187], v10 offset:24576
    v_mfma_f32_16x16x32_bf16 v[112:115], v[120:123], v[40:43], v[112:115]
    v_mfma_f32_32x32x16_bf16 v[16:31], v[44:47], v[172:175], v[16:31]
    ds_read_b64_tr_b16 v[60:61], v12 offset:30720
    ds_read_b64_tr_b16 v[62:63], v12 offset:31232
    ds_read_b128 v[188:191], v11 offset:24576
    v_mfma_f32_16x16x32_bf16 v[112:115], v[120:123], v[44:47], v[112:115]
    s_waitcnt lgkmcnt(0)
    s_barrier
    v_mfma_f32_32x32x16_bf16 v[16:31], v[48:51], v[176:179], v[16:31]
    ds_read_b64_tr_b16 v[32:33], v12 offset:32768
    ds_read_b64_tr_b16 v[34:35], v12 offset:33280
    ds_read_b128 v[192:195], v8 offset:32768
    v_mfma_f32_16x16x32_bf16 v[112:115], v[120:123], v[48:51], v[112:115]
    v_mfma_f32_32x32x16_bf16 v[16:31], v[52:55], v[180:183], v[16:31]
    ds_read_b64_tr_b16 v[36:37], v12 offset:34816
    ds_read_b64_tr_b16 v[38:39], v12 offset:35328
    ds_read_b128 v[196:199], v9 offset:32768
    v_mfma_f32_16x16x32_bf16 v[112:115], v[120:123], v[52:55], v[112:115]
    v_mfma_f32_32x32x16_bf16 v[16:31], v[56:59], v[184:187], v[16:31]
    ds_read_b64_tr_b16 v[40:41], v12 offset:36864
    ds_read_b64_tr_b16 v[42:43], v12 offset:37376
    ds_read_b128 v[200:203], v10 offset:32768
    v_mfma_f32_16x16x32_bf16 v[112:115], v[120:123], v[56:59], v[112:115]
    v_mfma_f32_32x32x16_bf16 v[16:31], v[60:63], v[188:191], v[16:31]
    ds_read_b64_tr_b16 v[44:45], v12 offset:38912
    ds_read_b64_tr_b16 v[46:47], v12 offset:39424
    ds_read_b128 v[204:207], v11 offset:32768
    v_mfma_f32_16x16x32_bf16 v[112:115], v[120:123], v[60:63], v[112:115]
    buffer_load_dwordx4 v[64:67], v126, s[12:15], s71 offen sc1
    buffer_load_dwordx4 v[68:71], v126, s[12:15], s3 offen sc1
    s_waitcnt lgkmcnt(0)
    s_barrier
    v_mfma_f32_32x32x16_bf16 v[16:31], v[32:35], v[192:195], v[16:31]
    ds_read_b64_tr_b16 v[48:49], v12 offset:40960
    ds_read_b64_tr_b16 v[50:51], v12 offset:41472
    ds_read_b128 v[208:211], v8 offset:40960
    v_mfma_f32_16x16x32_bf16 v[112:115], v[120:123], v[32:35], v[112:115]
    v_mfma_f32_32x32x16_bf16 v[16:31], v[36:39], v[196:199], v[16:31]
    ds_read_b64_tr_b16 v[52:53], v12 offset:43008
    ds_read_b64_tr_b16 v[54:55], v12 offset:43520
    ds_read_b128 v[212:215], v9 offset:40960
    v_mfma_f32_16x16x32_bf16 v[112:115], v[120:123], v[36:39], v[112:115]
    v_mfma_f32_32x32x16_bf16 v[16:31], v[40:43], v[200:203], v[16:31]
    ds_read_b64_tr_b16 v[56:57], v12 offset:45056
    ds_read_b64_tr_b16 v[58:59], v12 offset:45568
    ds_read_b128 v[216:219], v10 offset:40960
    v_mfma_f32_16x16x32_bf16 v[112:115], v[120:123], v[40:43], v[112:115]
    v_mfma_f32_32x32x16_bf16 v[16:31], v[44:47], v[204:207], v[16:31]
    ds_read_b64_tr_b16 v[60:61], v12 offset:47104
    ds_read_b64_tr_b16 v[62:63], v12 offset:47616
    ds_read_b128 v[220:223], v11 offset:40960
    v_mfma_f32_16x16x32_bf16 v[112:115], v[120:123], v[44:47], v[112:115]
    s_waitcnt lgkmcnt(0)
    s_barrier
    v_mfma_f32_32x32x16_bf16 v[16:31], v[48:51], v[208:211], v[16:31]
    ds_read_b64_tr_b16 v[32:33], v12 offset:49152
    ds_read_b64_tr_b16 v[34:35], v12 offset:49664
    ds_read_b128 v[224:227], v8 offset:49152
    v_mfma_f32_16x16x32_bf16 v[112:115], v[120:123], v[48:51], v[112:115]
    v_mfma_f32_32x32x16_bf16 v[16:31], v[52:55], v[212:215], v[16:31]
    ds_read_b64_tr_b16 v[36:37], v12 offset:51200
    ds_read_b64_tr_b16 v[38:39], v12 offset:51712
    ds_read_b128 v[228:231], v9 offset:49152
    v_mfma_f32_16x16x32_bf16 v[112:115], v[120:123], v[52:55], v[112:115]
    v_mfma_f32_32x32x16_bf16 v[16:31], v[56:59], v[216:219], v[16:31]
    ds_read_b64_tr_b16 v[40:41], v12 offset:53248
    ds_read_b64_tr_b16 v[42:43], v12 offset:53760
    ds_read_b128 v[232:235], v10 offset:49152
    v_mfma_f32_16x16x32_bf16 v[112:115], v[120:123], v[56:59], v[112:115]
    v_mfma_f32_32x32x16_bf16 v[16:31], v[60:63], v[220:223], v[16:31]
    ds_read_b64_tr_b16 v[44:45], v12 offset:55296
    ds_read_b64_tr_b16 v[46:47], v12 offset:55808
    ds_read_b128 v[236:239], v11 offset:49152
    v_mfma_f32_16x16x32_bf16 v[112:115], v[120:123], v[60:63], v[112:115]
    s_waitcnt lgkmcnt(10)
    v_mfma_f32_16x16x32_bf16 v[112:115], v[120:123], v[32:35], v[112:115]
    s_waitcnt lgkmcnt(7)
    v_mfma_f32_16x16x32_bf16 v[112:115], v[120:123], v[36:39], v[112:115]
    s_waitcnt lgkmcnt(4)
    v_mfma_f32_16x16x32_bf16 v[112:115], v[120:123], v[40:43], v[112:115]
    s_waitcnt lgkmcnt(1)
    v_mfma_f32_16x16x32_bf16 v[112:115], v[120:123], v[44:47], v[112:115]
    s_waitcnt lgkmcnt(0)
    v_mfma_f32_32x32x16_bf16 v[16:31], v[32:35], v[224:227], v[16:31]
    s_waitcnt vmcnt(0)
    v_cmp_ne_u32 vcc, s36, v67
    s_cbranch_vccnz RETRY_11
OK_13:
    v_xor_b32 v72, 0x80000000, v64
    v_cndmask_b32 v72, 0, v72, s[54:55]
    v_lshrrev_b32 v73, 16, v72
    v_or_b32 v74, v72, v73
    v_mfma_f32_32x32x16_bf16 v[16:31], v[36:39], v[228:231], v[16:31]
    v_or_b32 v75, v72, v73
    v_or_b32 v73, v72, v73
    v_mov_b32 v72, v74
    v_mov_b32 v64, v65
    v_cvt_pk_bf16_f32 v84, v112, v112
    v_mfma_f32_32x32x16_bf16 v[16:31], v[40:43], v[232:235], v[16:31]
    v_and_b32 v85, 0xffff0000, v84
    v_sub_f32 v85, v112, v85
    v_cvt_pk_bf16_f32 v76, v85, v112
    ds_write_b32 v127, v76
    v_mfma_f32_32x32x16_bf16 v[16:31], v[44:47], v[236:239], v[16:31]
    v_mfma_f32_32x32x16_bf16 v[16:31], v[76:79], v[72:75], v[16:31]
    s_waitcnt lgkmcnt(0)
    s_nop 10
    v_pk_mul_f32 v[16:17], v[16:17], v[64:65]
    v_cvt_pk_bf16_f32 v104, v16, v17
    v_pk_mul_f32 v[18:19], v[18:19], v[64:65]
    v_cvt_pk_bf16_f32 v105, v18, v19
    v_pk_mul_f32 v[20:21], v[20:21], v[64:65]
    v_cvt_pk_bf16_f32 v106, v20, v21
    v_pk_mul_f32 v[22:23], v[22:23], v[64:65]
    v_cvt_pk_bf16_f32 v107, v22, v23
    buffer_store_dwordx4 v[104:107], v124, s[12:15], s74 offen offset:0 sc1
    v_pk_mul_f32 v[24:25], v[24:25], v[64:65]
    v_cvt_pk_bf16_f32 v108, v24, v25
    v_pk_mul_f32 v[26:27], v[26:27], v[64:65]
    v_cvt_pk_bf16_f32 v109, v26, v27
    v_pk_mul_f32 v[28:29], v[28:29], v[64:65]
    v_cvt_pk_bf16_f32 v110, v28, v29
    v_pk_mul_f32 v[30:31], v[30:31], v[64:65]
    v_cvt_pk_bf16_f32 v111, v30, v31
    buffer_store_dwordx4 v[108:111], v124, s[12:15], s74 offen offset:1024 sc1
    s_barrier
    s_branch L_EJOIN
L_EARLY_V:
    s_lshl_b32 s74, s74, 11
    s_add_u32 s74, s74, 3145728
    s_lshl1_add_u32 s43, s39, s48
    s_lshl_b32 s43, s43, 5
    s_sub_u32 s43, s43, 448
    v_add_u32 v84, s43, v4
    v_mul_u32_u24 v85, 2341, v84
    v_lshrrev_b32 v85, 16, v85
    v_mul_u32_u24 v86, 130624, v85
    v_lshl_add_u32 v86, v84, 4, v86
    v_lshl_add_u32 v124, v5, 9, v86
    v_mov_b32 v120, 0x3f803f80
    v_mov_b32 v112, 0
    v_mov_b32 v113, 0
    v_mov_b32 v114, 0
    v_mov_b32 v115, 0
    v_lshlrev_b32 v85, 4, v5
    v_mov_b32 v86, 157696
    v_lshlrev_b32 v87, 2, v4
    v_add_u32 v87, 157760, v87
    s_waitcnt lgkmcnt(0)
    s_mul_i32 s36, s36, 0x9e3779b1
    s_add_u32 s36, s36, 0x7f4a7c15
    v_mov_b32 v119, s36
    ds_write_b32 v86, v119
    ds_write_b32 v87, v112
    s_min_u32 s62, s62, 111
    s_cmp_ge_u32 s62, 56
    s_cselect_b32 s24, s60, s24
    s_cselect_b32 s25, s61, s25
    s_cselect_b32 s41, 56, 0
    s_sub_u32 s41, s62, s41
    s_cmp_ge_u32 s41, 28
    s_cselect_b32 s42, 799232, 0
    s_lshl_b32 s41, s41, 7
    s_add_u32 s41, s41, s42
    s_and_b32 s43, s2, 8
    s_lshl_b32 s43, s43, 3
    s_add_u32 s100, s41, s43
    s_mul_i32 s41, s62, 9363
    s_lshr_b32 s41, s41, 16
    s_mul_i32 s41, s41, 99456
    s_lshl_b32 s42, s62, 7
    s_add_u32 s41, s41, s42
    s_add_u32 s101, s41, s43
    s_lshl2_add_u32 s41, s38, s40
    s_lshl4_add_u32 s41, s41, s39
    s_lshl_b32 s41, s41, 7
    s_add_u32 s41, s41, 65536
    v_mul_u32_u24 v84, 262144, v5
    buffer_load_dword v255, v84, s[12:15], s41 offen sc1
    s_lshl_b32 s42, s46, 5
    s_add_u32 s42, s42, 32768
    s_waitcnt vmcnt(2)
    v_dot2c_f32_bf16 v112, v96, v120
    v_dot2c_f32_bf16 v113, v96, v96
    v_dot2c_f32_bf16 v114, v96, v104
    v_dot2c_f32_bf16 v115, v104, v120
    v_dot2c_f32_bf16 v112, v97, v120
    v_dot2c_f32_bf16 v113, v97, v97
    v_dot2c_f32_bf16 v114, v97, v105
    v_dot2c_f32_bf16 v115, v105, v120
    v_dot2c_f32_bf16 v112, v98, v120
    v_dot2c_f32_bf16 v113, v98, v98
    v_dot2c_f32_bf16 v114, v98, v106
    v_dot2c_f32_bf16 v115, v106, v120
    v_dot2c_f32_bf16 v112, v99, v120
    v_dot2c_f32_bf16 v113, v99, v99
    v_dot2c_f32_bf16 v114, v99, v107
    v_dot2c_f32_bf16 v115, v107, v120
    v_dot2c_f32_bf16 v112, v100, v120
    v_dot2c_f32_bf16 v113, v100, v100
    v_dot2c_f32_bf16 v114, v100, v108
    v_dot2c_f32_bf16 v115, v108, v120
    v_dot2c_f32_bf16 v112, v101, v120
    v_dot2c_f32_bf16 v113, v101, v101
    v_dot2c_f32_bf16 v114, v101, v109
    v_dot2c_f32_bf16 v115, v109, v120
    v_dot2c_f32_bf16 v112, v102, v120
    v_dot2c_f32_bf16 v113, v102, v102
    v_dot2c_f32_bf16 v114, v102, v110
    v_dot2c_f32_bf16 v115, v110, v120
    v_dot2c_f32_bf16 v112, v103, v120
    v_dot2c_f32_bf16 v113, v103, v103
    v_dot2c_f32_bf16 v114, v103, v111
    v_dot2c_f32_bf16 v115, v111, v120
    v_add_f32_dpp v112, v112, v112 row_shr:1 row_mask:0xf bank_mask:0xf
    v_add_f32_dpp v113, v113, v113 row_shr:1 row_mask:0xf bank_mask:0xf
    v_add_f32_dpp v114, v114, v114 row_shr:1 row_mask:0xf bank_mask:0xf
    v_add_f32_dpp v115, v115, v115 row_shr:1 row_mask:0xf bank_mask:0xf
    v_add_f32_dpp v112, v112, v112 row_shr:2 row_mask:0xf bank_mask:0xf
    v_add_f32_dpp v113, v113, v113 row_shr:2 row_mask:0xf bank_mask:0xf
    v_add_f32_dpp v114, v114, v114 row_shr:2 row_mask:0xf bank_mask:0xf
    v_add_f32_dpp v115, v115, v115 row_shr:2 row_mask:0xf bank_mask:0xf
    v_add_f32_dpp v112, v112, v112 row_shr:4 row_mask:0xf bank_mask:0xf
    v_add_f32_dpp v113, v113, v113 row_shr:4 row_mask:0xf bank_mask:0xf
    v_add_f32_dpp v114, v114, v114 row_shr:4 row_mask:0xf bank_mask:0xf
    v_add_f32_dpp v115, v115, v115 row_shr:4 row_mask:0xf bank_mask:0xf
    v_add_f32_dpp v112, v112, v112 row_shr:8 row_mask:0xf bank_mask:0xf
    v_add_f32_dpp v113, v113, v113 row_shr:8 row_mask:0xf bank_mask:0xf
    v_add_f32_dpp v114, v114, v114 row_shr:8 row_mask:0xf bank_mask:0xf
    v_add_f32_dpp v115, v115, v115 row_shr:8 row_mask:0xf bank_mask:0xf
    v_add_f32_dpp v112, v112, v112 row_bcast:15 row_mask:0xa bank_mask:0xf
    v_add_f32_dpp v113, v113, v113 row_bcast:15 row_mask:0xa bank_mask:0xf
    v_add_f32_dpp v114, v114, v114 row_bcast:15 row_mask:0xa bank_mask:0xf
    v_add_f32_dpp v115, v115, v115 row_bcast:15 row_mask:0xa bank_mask:0xf
    v_mul_f32 v112, 0x3b124925, v112
    v_mul_f32 v113, 0x3b124925, v113
    v_fma_f32 v113, -v112, v112, v113
    v_max_f32 v113, 0, v113
    v_cvt_pk_bf16_f32 v84, v112, v113
    v_lshlrev_b32 v116, 16, v84
    v_and_b32 v84, 0xffff0000, v84
    v_add_f32 v84, 0x3727c5ac, v84
    v_cvt_pk_bf16_f32 v84, v84, v84
    v_and_b32 v84, 0xffff0000, v84
    v_sqrt_f32 v84, v84
    v_fma_f32 v114, -v116, v115, v114
    v_cvt_pk_bf16_f32 v84, v84, v84
    v_and_b32 v84, 0xffff0000, v84
    v_rcp_f32 v117, v84
    s_mov_b32 exec_lo, 0x80000000
    s_mov_b32 exec_hi, 0x80000000
    v_mul_f32 v118, v114, v117
    buffer_store_dwordx4 v[116:119], v85, s[12:15], s42 offen sc1
    s_mov_b64 exec, -1
    v_lshrrev_b32 v120, 2, v0
    v_xor_b32 v120, v120, v0
    v_and_b32 v120, 4, v120
    v_cmp_eq_u32 vcc, 0, v120
    v_mov_b32 v121, 0x3f803f80
    s_nop 0
    v_cndmask_b32 v120, 0, v121, vcc
    v_mov_b32 v121, v120
    v_mov_b32 v122, v120
    v_mov_b32 v123, v120
    v_mov_b32 v77, 0
    s_waitcnt lgkmcnt(0)
    s_barrier
    ds_read_b64_tr_b16 v[32:33], v12 offset:0
    ds_read_b64_tr_b16 v[34:35], v12 offset:512
    ds_read_b128 v[128:131], v8 offset:0
    ds_read_b64_tr_b16 v[36:37], v12 offset:2048
    ds_read_b64_tr_b16 v[38:39], v12 offset:2560
    ds_read_b128 v[132:135], v9 offset:0
    ds_read_b64_tr_b16 v[40:41], v12 offset:4096
    ds_read_b64_tr_b16 v[42:43], v12 offset:4608
    ds_read_b128 v[136:139], v10 offset:0
    ds_read_b64_tr_b16 v[44:45], v12 offset:6144
    ds_read_b64_tr_b16 v[46:47], v12 offset:6656
    ds_read_b128 v[140:143], v11 offset:0
    s_waitcnt lgkmcnt(0)
    s_barrier
    v_mfma_f32_32x32x16_bf16 v[16:31], v[128:131], v[32:35], 0
    ds_read_b64_tr_b16 v[48:49], v12 offset:8192
    ds_read_b64_tr_b16 v[50:51], v12 offset:8704
    ds_read_b128 v[144:147], v8 offset:8192
    v_mfma_f32_16x16x32_bf16 v[112:115], v[120:123], v[32:35], 0
    v_mfma_f32_32x32x16_bf16 v[16:31], v[132:135], v[36:39], v[16:31]
    ds_read_b64_tr_b16 v[52:53], v12 offset:10240
    ds_read_b64_tr_b16 v[54:55], v12 offset:10752
    ds_read_b128 v[148:151], v9 offset:8192
    v_mfma_f32_16x16x32_bf16 v[112:115], v[120:123], v[36:39], v[112:115]
    v_mfma_f32_32x32x16_bf16 v[16:31], v[136:139], v[40:43], v[16:31]
    ds_read_b64_tr_b16 v[56:57], v12 offset:12288
    ds_read_b64_tr_b16 v[58:59], v12 offset:12800
    ds_read_b128 v[152:155], v10 offset:8192
    v_mfma_f32_16x16x32_bf16 v[112:115], v[120:123], v[40:43], v[112:115]
    v_mfma_f32_32x32x16_bf16 v[16:31], v[140:143], v[44:47], v[16:31]
    ds_read_b64_tr_b16 v[60:61], v12 offset:14336
    ds_read_b64_tr_b16 v[62:63], v12 offset:14848
    ds_read_b128 v[156:159], v11 offset:8192
    v_mfma_f32_16x16x32_bf16 v[112:115], v[120:123], v[44:47], v[112:115]
    s_waitcnt lgkmcnt(0)
    s_barrier
    v_mfma_f32_32x32x16_bf16 v[16:31], v[144:147], v[48:51], v[16:31]
    ds_read_b64_tr_b16 v[32:33], v12 offset:16384
    ds_read_b64_tr_b16 v[34:35], v12 offset:16896
    ds_read_b128 v[160:163], v8 offset:16384
    v_mfma_f32_16x16x32_bf16 v[112:115], v[120:123], v[48:51], v[112:115]
    v_mfma_f32_32x32x16_bf16 v[16:31], v[148:151], v[52:55], v[16:31]
    ds_read_b64_tr_b16 v[36:37], v12 offset:18432
    ds_read_b64_tr_b16 v[38:39], v12 offset:18944
    ds_read_b128 v[164:167], v9 offset:16384
    v_mfma_f32_16x16x32_bf16 v[112:115], v[120:123], v[52:55], v[112:115]
    v_mfma_f32_32x32x16_bf16 v[16:31], v[152:155], v[56:59], v[16:31]
    ds_read_b64_tr_b16 v[40:41], v12 offset:20480
    ds_read_b64_tr_b16 v[42:43], v12 offset:20992
    ds_read_b128 v[168:171], v10 offset:16384
    v_mfma_f32_16x16x32_bf16 v[112:115], v[120:123], v[56:59], v[112:115]
    v_mfma_f32_32x32x16_bf16 v[16:31], v[156:159], v[60:63], v[16:31]
    ds_read_b64_tr_b16 v[44:45], v12 offset:22528
    ds_read_b64_tr_b16 v[46:47], v12 offset:23040
    ds_read_b128 v[172:175], v11 offset:16384
    v_mfma_f32_16x16x32_bf16 v[112:115], v[120:123], v[60:63], v[112:115]
    s_waitcnt lgkmcnt(0)
    s_barrier
    v_mfma_f32_32x32x16_bf16 v[16:31], v[160:163], v[32:35], v[16:31]
    ds_read_b64_tr_b16 v[48:49], v12 offset:24576
    ds_read_b64_tr_b16 v[50:51], v12 offset:25088
    ds_read_b128 v[176:179], v8 offset:24576
    v_mfma_f32_16x16x32_bf16 v[112:115], v[120:123], v[32:35], v[112:115]
    v_mfma_f32_32x32x16_bf16 v[16:31], v[164:167], v[36:39], v[16:31]
    ds_read_b64_tr_b16 v[52:53], v12 offset:26624
    ds_read_b64_tr_b16 v[54:55], v12 offset:27136
    ds_read_b128 v[180:183], v9 offset:24576
    v_mfma_f32_16x16x32_bf16 v[112:115], v[120:123], v[36:39], v[112:115]
    v_mfma_f32_32x32x16_bf16 v[16:31], v[168:171], v[40:43], v[16:31]
    ds_read_b64_tr_b16 v[56:57], v12 offset:28672
    ds_read_b64_tr_b16 v[58:59], v12 offset:29184
    ds_read_b128 v[184:187], v10 offset:24576
    v_mfma_f32_16x16x32_bf16 v[112:115], v[120:123], v[40:43], v[112:115]
    v_mfma_f32_32x32x16_bf16 v[16:31], v[172:175], v[44:47], v[16:31]
    ds_read_b64_tr_b16 v[60:61], v12 offset:30720
    ds_read_b64_tr_b16 v[62:63], v12 offset:31232
    ds_read_b128 v[188:191], v11 offset:24576
    v_mfma_f32_16x16x32_bf16 v[112:115], v[120:123], v[44:47], v[112:115]
    s_waitcnt lgkmcnt(0)
    s_barrier
    v_mfma_f32_32x32x16_bf16 v[16:31], v[176:179], v[48:51], v[16:31]
    ds_read_b64_tr_b16 v[32:33], v12 offset:32768
    ds_read_b64_tr_b16 v[34:35], v12 offset:33280
    ds_read_b128 v[192:195], v8 offset:32768
    v_mfma_f32_16x16x32_bf16 v[112:115], v[120:123], v[48:51], v[112:115]
    v_mfma_f32_32x32x16_bf16 v[16:31], v[180:183], v[52:55], v[16:31]
    ds_read_b64_tr_b16 v[36:37], v12 offset:34816
    ds_read_b64_tr_b16 v[38:39], v12 offset:35328
    ds_read_b128 v[196:199], v9 offset:32768
    v_mfma_f32_16x16x32_bf16 v[112:115], v[120:123], v[52:55], v[112:115]
    v_mfma_f32_32x32x16_bf16 v[16:31], v[184:187], v[56:59], v[16:31]
    ds_read_b64_tr_b16 v[40:41], v12 offset:36864
    ds_read_b64_tr_b16 v[42:43], v12 offset:37376
    ds_read_b128 v[200:203], v10 offset:32768
    v_mfma_f32_16x16x32_bf16 v[112:115], v[120:123], v[56:59], v[112:115]
    v_mfma_f32_32x32x16_bf16 v[16:31], v[188:191], v[60:63], v[16:31]
    ds_read_b64_tr_b16 v[44:45], v12 offset:38912
    ds_read_b64_tr_b16 v[46:47], v12 offset:39424
    ds_read_b128 v[204:207], v11 offset:32768
    v_mfma_f32_16x16x32_bf16 v[112:115], v[120:123], v[60:63], v[112:115]
    buffer_load_dwordx4 v[64:67], v126, s[12:15], s71 offen sc1
    buffer_load_dwordx4 v[68:71], v126, s[12:15], s3 offen sc1
    s_waitcnt lgkmcnt(0)
    s_barrier
    v_mfma_f32_32x32x16_bf16 v[16:31], v[192:195], v[32:35], v[16:31]
    ds_read_b64_tr_b16 v[48:49], v12 offset:40960
    ds_read_b64_tr_b16 v[50:51], v12 offset:41472
    ds_read_b128 v[208:211], v8 offset:40960
    v_mfma_f32_16x16x32_bf16 v[112:115], v[120:123], v[32:35], v[112:115]
    v_mfma_f32_32x32x16_bf16 v[16:31], v[196:199], v[36:39], v[16:31]
    ds_read_b64_tr_b16 v[52:53], v12 offset:43008
    ds_read_b64_tr_b16 v[54:55], v12 offset:43520
    ds_read_b128 v[212:215], v9 offset:40960
    v_mfma_f32_16x16x32_bf16 v[112:115], v[120:123], v[36:39], v[112:115]
    v_mfma_f32_32x32x16_bf16 v[16:31], v[200:203], v[40:43], v[16:31]
    ds_read_b64_tr_b16 v[56:57], v12 offset:45056
    ds_read_b64_tr_b16 v[58:59], v12 offset:45568
    ds_read_b128 v[216:219], v10 offset:40960
    v_mfma_f32_16x16x32_bf16 v[112:115], v[120:123], v[40:43], v[112:115]
    v_mfma_f32_32x32x16_bf16 v[16:31], v[204:207], v[44:47], v[16:31]
    ds_read_b64_tr_b16 v[60:61], v12 offset:47104
    ds_read_b64_tr_b16 v[62:63], v12 offset:47616
    ds_read_b128 v[220:223], v11 offset:40960
    v_mfma_f32_16x16x32_bf16 v[112:115], v[120:123], v[44:47], v[112:115]
    s_waitcnt lgkmcnt(0)
    s_barrier
    v_mfma_f32_32x32x16_bf16 v[16:31], v[208:211], v[48:51], v[16:31]
    ds_read_b64_tr_b16 v[32:33], v12 offset:49152
    ds_read_b64_tr_b16 v[34:35], v12 offset:49664
    ds_read_b128 v[224:227], v8 offset:49152
    v_mfma_f32_16x16x32_bf16 v[112:115], v[120:123], v[48:51], v[112:115]
    v_mfma_f32_32x32x16_bf16 v[16:31], v[212:215], v[52:55], v[16:31]
    ds_read_b64_tr_b16 v[36:37], v12 offset:51200
    ds_read_b64_tr_b16 v[38:39], v12 offset:51712
    ds_read_b128 v[228:231], v9 offset:49152
    v_mfma_f32_16x16x32_bf16 v[112:115], v[120:123], v[52:55], v[112:115]
    v_mfma_f32_32x32x16_bf16 v[16:31], v[216:219], v[56:59], v[16:31]
    ds_read_b64_tr_b16 v[40:41], v12 offset:53248
    ds_read_b64_tr_b16 v[42:43], v12 offset:53760
    ds_read_b128 v[232:235], v10 offset:49152
    v_mfma_f32_16x16x32_bf16 v[112:115], v[120:123], v[56:59], v[112:115]
    v_mfma_f32_32x32x16_bf16 v[16:31], v[220:223], v[60:63], v[16:31]
    ds_read_b64_tr_b16 v[44:45], v12 offset:55296
    ds_read_b64_tr_b16 v[46:47], v12 offset:55808
    ds_read_b128 v[236:239], v11 offset:49152
    v_mfma_f32_16x16x32_bf16 v[112:115], v[120:123], v[60:63], v[112:115]
    s_waitcnt lgkmcnt(10)
    v_mfma_f32_16x16x32_bf16 v[112:115], v[120:123], v[32:35], v[112:115]
    s_waitcnt lgkmcnt(7)
    v_mfma_f32_16x16x32_bf16 v[112:115], v[120:123], v[36:39], v[112:115]
    s_waitcnt lgkmcnt(4)
    v_mfma_f32_16x16x32_bf16 v[112:115], v[120:123], v[40:43], v[112:115]
    s_waitcnt lgkmcnt(1)
    v_mfma_f32_16x16x32_bf16 v[112:115], v[120:123], v[44:47], v[112:115]
    s_waitcnt lgkmcnt(0)
    v_mfma_f32_32x32x16_bf16 v[16:31], v[224:227], v[32:35], v[16:31]
    s_waitcnt vmcnt(0)
    v_cmp_ne_u32 vcc, s36, v67
    s_cbranch_vccnz RETRY_14
OK_16:
    ds_write_b32 v249, v65
    ds_read_b128 v[88:91], v250 offset:0
    ds_read_b128 v[92:95], v250 offset:32
    ds_read_b128 v[96:99], v250 offset:64
    v_mfma_f32_32x32x16_bf16 v[16:31], v[228:231], v[36:39], v[16:31]
    ds_read_b128 v[100:103], v250 offset:96
    v_xor_b32 v72, 0x80000000, v64
    v_cndmask_b32 v72, 0, v72, s[54:55]
    v_lshrrev_b32 v73, 16, v72
    v_or_b32 v74, v72, v73
    v_mfma_f32_32x32x16_bf16 v[16:31], v[232:235], v[40:43], v[16:31]
    v_or_b32 v75, v72, v73
    v_or_b32 v73, v72, v73
    v_mov_b32 v72, v74
    v_cvt_pk_bf16_f32 v84, v112, v112
    v_and_b32 v85, 0xffff0000, v84
    v_mfma_f32_32x32x16_bf16 v[16:31], v[236:239], v[44:47], v[16:31]
    v_sub_f32 v85, v112, v85
    v_cvt_pk_bf16_f32 v76, v85, v112
    ds_write_b32 v127, v76
    s_nop 0
    v_mfma_f32_32x32x16_bf16 v[16:31], v[72:75], v[76:79], v[16:31]
    s_waitcnt lgkmcnt(0)
    s_nop 10
    v_pk_mul_f32 v[16:17], v[16:17], v[88:89]
    v_cvt_pk_bf16_f32 v104, v16, v17
    v_pk_mul_f32 v[18:19], v[18:19], v[90:91]
    v_cvt_pk_bf16_f32 v105, v18, v19
    v_pk_mul_f32 v[20:21], v[20:21], v[92:93]
    v_cvt_pk_bf16_f32 v106, v20, v21
    v_pk_mul_f32 v[22:23], v[22:23], v[94:95]
    v_cvt_pk_bf16_f32 v107, v22, v23
    buffer_store_dwordx4 v[104:107], v124, s[12:15], s74 offen offset:0 sc1
    v_pk_mul_f32 v[24:25], v[24:25], v[96:97]
    v_cvt_pk_bf16_f32 v108, v24, v25
    v_pk_mul_f32 v[26:27], v[26:27], v[98:99]
    v_cvt_pk_bf16_f32 v109, v26, v27
    v_pk_mul_f32 v[28:29], v[28:29], v[100:101]
    v_cvt_pk_bf16_f32 v110, v28, v29
    v_pk_mul_f32 v[30:31], v[30:31], v[102:103]
    v_cvt_pk_bf16_f32 v111, v30, v31
    buffer_store_dwordx4 v[108:111], v124, s[12:15], s74 offen offset:1024 sc1
    s_barrier
L_EJOIN:
    s_cmp_eq_u32 s48, 0
    s_cbranch_scc1 L_EVEN
    v_subrev_u32 v8, 40960, v8
    v_subrev_u32 v9, 40960, v9
    v_subrev_u32 v10, 40960, v10
    v_subrev_u32 v11, 40960, v11
    ds_read_b128 v[128:131], v8 offset:0
    ds_read_b128 v[132:135], v9 offset:0
    ds_read_b128 v[136:139], v10 offset:0
    ds_read_b128 v[140:143], v11 offset:0
    ds_read_b128 v[144:147], v8 offset:8192
    ds_read_b128 v[148:151], v9 offset:8192
    ds_read_b128 v[152:155], v10 offset:8192
    ds_read_b128 v[156:159], v11 offset:8192
    ds_read_b128 v[160:163], v8 offset:16384
    ds_read_b128 v[164:167], v9 offset:16384
    ds_read_b128 v[168:171], v10 offset:16384
    ds_read_b128 v[172:175], v11 offset:16384
    ds_read_b128 v[176:179], v8 offset:24576
    ds_read_b128 v[180:183], v9 offset:24576
    ds_read_b128 v[184:187], v10 offset:24576
    ds_read_b128 v[188:191], v11 offset:24576
    ds_read_b128 v[192:195], v8 offset:32768
    ds_read_b128 v[196:199], v9 offset:32768
    ds_read_b128 v[200:203], v10 offset:32768
    ds_read_b128 v[204:207], v11 offset:32768
    ds_read_b128 v[208:211], v8 offset:40960
    ds_read_b128 v[212:215], v9 offset:40960
    ds_read_b128 v[216:219], v10 offset:40960
    ds_read_b128 v[220:223], v11 offset:40960
    ds_read_b128 v[224:227], v8 offset:49152
    ds_read_b128 v[228:231], v9 offset:49152
    ds_read_b128 v[232:235], v10 offset:49152
    ds_read_b128 v[236:239], v11 offset:49152
L_EVEN:
L_QEARLY:
    s_nop 0
    v_cmp_ne_u32 vcc, s36, v71
    s_cbranch_vccnz RETRY_17
OK_19:
    v_xor_b32 v72, 0x80000000, v68
    v_cndmask_b32 v72, 0, v72, s[54:55]
    v_lshrrev_b32 v73, 16, v72
    v_or_b32 v74, v72, v73
    v_or_b32 v75, v72, v73
    v_or_b32 v73, v72, v73
    v_mov_b32 v72, v74
    v_mul_f32 v68, 0x3e8b97f6, v69
    v_mul_f32 v69, 0x3e8b97f6, v69
    s_bitcmp1_b32 s39, 0
    s_cselect_b32 s56, 0, -1
    s_mov_b32 s57, -1
    s_mov_b32 s34, -1
    s_cselect_b32 s35, -1, 0
    s_mov_b32 s70, 15
    s_and_b32 s41, s38, 3
    s_lshl_b32 s69, -1, s41
    s_mov_b32 s37, s36
    v_mov_b32 v120, 0x3f803f80
    v_mov_b32 v121, 0x3f803f80
    v_mov_b32 v122, 0x3f803f80
    v_mov_b32 v123, 0x3f803f80
    s_and_b32 s42, s40, 4
    s_add_u32 s41, s40, 1
    s_and_b32 s41, s41, 3
    s_or_b32 s41, s41, s42
    s_lshl_b32 s41, s41, 12
    s_add_u32 s65, s41, 100352
    s_add_u32 s41, s40, 2
    s_and_b32 s41, s41, 3
    s_or_b32 s41, s41, s42
    s_lshl_b32 s41, s41, 12
    s_add_u32 s66, s41, 100352
    s_add_u32 s41, s40, 3
    s_and_b32 s41, s41, 3
    s_or_b32 s41, s41, s42
    s_lshl_b32 s41, s41, 12
    s_add_u32 s67, s41, 100352
    s_add_u32 s41, s40, 4
    s_and_b32 s41, s41, 3
    s_or_b32 s41, s41, s42
    s_lshl_b32 s41, s41, 12
    s_add_u32 s68, s41, 100352
    v_add_u32 v1, s68, v6
    s_cmp_lt_u32 s2, 224
    s_cselect_b32 s63, s40, 8
    s_waitcnt lgkmcnt(0)
    s_barrier
    ds_read_b64_tr_b16 v[32:33], v13 offset:0
    ds_read_b64_tr_b16 v[34:35], v13 offset:256
    ds_read_b64_tr_b16 v[36:37], v13 offset:1024
    ds_read_b64_tr_b16 v[38:39], v13 offset:1280
    ds_read_b64_tr_b16 v[40:41], v13 offset:2048
    ds_read_b64_tr_b16 v[42:43], v13 offset:2304
    ds_read_b64_tr_b16 v[44:45], v13 offset:3072
    ds_read_b64_tr_b16 v[46:47], v13 offset:3328
    ds_read_b64_tr_b16 v[48:49], v13 offset:4096
    ds_read_b64_tr_b16 v[50:51], v13 offset:4352
    v_mov_b32 v84, s36
    s_mov_b64 exec, 7
    s_waitcnt vmcnt(0)
    buffer_store_dword v84, v14, s[12:15], s75 offen sc1
    s_mov_b64 exec, -1
    s_waitcnt lgkmcnt(8)
    v_mfma_f32_32x32x16_bf16 v[16:31], v[32:35], v[128:131], 0
    ds_read_b64_tr_b16 v[52:53], v13 offset:5120
    ds_read_b64_tr_b16 v[54:55], v13 offset:5376
    s_waitcnt lgkmcnt(8)
    v_mfma_f32_32x32x16_bf16 v[16:31], v[36:39], v[132:135], v[16:31]
    ds_read_b64_tr_b16 v[56:57], v13 offset:6144
    ds_read_b64_tr_b16 v[58:59], v13 offset:6400
    s_waitcnt lgkmcnt(8)
    v_mfma_f32_32x32x16_bf16 v[16:31], v[40:43], v[136:139], v[16:31]
    ds_read_b64_tr_b16 v[60:61], v13 offset:7168
    ds_read_b64_tr_b16 v[62:63], v13 offset:7424
    s_waitcnt lgkmcnt(8)
    v_mfma_f32_32x32x16_bf16 v[16:31], v[44:47], v[140:143], v[16:31]
    ds_read_b64_tr_b16 v[32:33], v13 offset:8192
    ds_read_b64_tr_b16 v[34:35], v13 offset:8448
    s_waitcnt lgkmcnt(8)
    v_mfma_f32_32x32x16_bf16 v[16:31], v[48:51], v[144:147], v[16:31]
    ds_read_b64_tr_b16 v[36:37], v13 offset:9216
    ds_read_b64_tr_b16 v[38:39], v13 offset:9472
    s_waitcnt lgkmcnt(8)
    v_mfma_f32_32x32x16_bf16 v[16:31], v[52:55], v[148:151], v[16:31]
    ds_read_b64_tr_b16 v[40:41], v13 offset:10240
    ds_read_b64_tr_b16 v[42:43], v13 offset:10496
    s_waitcnt lgkmcnt(8)
    v_mfma_f32_32x32x16_bf16 v[16:31], v[56:59], v[152:155], v[16:31]
    ds_read_b64_tr_b16 v[44:45], v13 offset:11264
    ds_read_b64_tr_b16 v[46:47], v13 offset:11520
    s_waitcnt lgkmcnt(8)
    v_mfma_f32_32x32x16_bf16 v[16:31], v[60:63], v[156:159], v[16:31]
    ds_read_b64_tr_b16 v[48:49], v13 offset:12288
    ds_read_b64_tr_b16 v[50:51], v13 offset:12544
    s_waitcnt lgkmcnt(8)
    v_mfma_f32_32x32x16_bf16 v[16:31], v[32:35], v[160:163], v[16:31]
    ds_read_b64_tr_b16 v[52:53], v13 offset:13312
    ds_read_b64_tr_b16 v[54:55], v13 offset:13568
    s_waitcnt lgkmcnt(8)
    v_mfma_f32_32x32x16_bf16 v[16:31], v[36:39], v[164:167], v[16:31]
    ds_read_b64_tr_b16 v[56:57], v13 offset:14336
    ds_read_b64_tr_b16 v[58:59], v13 offset:14592
    s_waitcnt lgkmcnt(8)
    v_mfma_f32_32x32x16_bf16 v[16:31], v[40:43], v[168:171], v[16:31]
    ds_read_b64_tr_b16 v[60:61], v13 offset:15360
    ds_read_b64_tr_b16 v[62:63], v13 offset:15616
    s_waitcnt lgkmcnt(8)
    v_mfma_f32_32x32x16_bf16 v[16:31], v[44:47], v[172:175], v[16:31]
    s_waitcnt lgkmcnt(6)
    v_mfma_f32_32x32x16_bf16 v[16:31], v[48:51], v[176:179], v[16:31]
    s_waitcnt lgkmcnt(4)
    v_mfma_f32_32x32x16_bf16 v[16:31], v[52:55], v[180:183], v[16:31]
    s_barrier
    ds_read_b64_tr_b16 v[32:33], v13 offset:16384
    ds_read_b64_tr_b16 v[34:35], v13 offset:16640
    ds_read_b64_tr_b16 v[36:37], v13 offset:17408
    ds_read_b64_tr_b16 v[38:39], v13 offset:17664
    ds_read_b64_tr_b16 v[40:41], v13 offset:18432
    ds_read_b64_tr_b16 v[42:43], v13 offset:18688
    s_waitcnt lgkmcnt(8)
    v_mfma_f32_32x32x16_bf16 v[16:31], v[56:59], v[184:187], v[16:31]
    ds_read_b64_tr_b16 v[44:45], v13 offset:19456
    ds_read_b64_tr_b16 v[46:47], v13 offset:19712
    s_waitcnt lgkmcnt(8)
    v_mfma_f32_32x32x16_bf16 v[16:31], v[60:63], v[188:191], v[16:31]
    ds_read_b64_tr_b16 v[48:49], v13 offset:20480
    ds_read_b64_tr_b16 v[50:51], v13 offset:20736
    v_mov_b32 v160, v248
    v_mov_b32 v161, v248
    v_mov_b64 v[162:163], v[160:161]
    s_waitcnt lgkmcnt(8)
    v_mfma_f32_32x32x16_bf16 v[16:31], v[32:35], v[192:195], v[16:31]
    ds_read_b64_tr_b16 v[52:53], v13 offset:21504
    ds_read_b64_tr_b16 v[54:55], v13 offset:21760
    v_mov_b64 v[164:165], v[160:161]
    v_mov_b64 v[166:167], v[160:161]
    v_mov_b64 v[176:177], v[160:161]
    s_waitcnt lgkmcnt(8)
    v_mfma_f32_32x32x16_bf16 v[16:31], v[36:39], v[196:199], v[16:31]
    ds_read_b64_tr_b16 v[56:57], v13 offset:22528
    ds_read_b64_tr_b16 v[58:59], v13 offset:22784
    v_mov_b64 v[178:179], v[160:161]
    v_mov_b64 v[180:181], v[160:161]
    v_mov_b64 v[182:183], v[160:161]
    s_waitcnt lgkmcnt(8)
    v_mfma_f32_32x32x16_bf16 v[16:31], v[40:43], v[200:203], v[16:31]
    ds_read_b64_tr_b16 v[60:61], v13 offset:23552
    ds_read_b64_tr_b16 v[62:63], v13 offset:23808
    s_waitcnt lgkmcnt(8)
    v_mfma_f32_32x32x16_bf16 v[16:31], v[44:47], v[204:207], v[16:31]
    ds_read_b64_tr_b16 v[32:33], v13 offset:24576
    ds_read_b64_tr_b16 v[34:35], v13 offset:24832
    s_waitcnt lgkmcnt(8)
    v_mfma_f32_32x32x16_bf16 v[16:31], v[48:51], v[208:211], v[16:31]
    ds_read_b64_tr_b16 v[36:37], v13 offset:25600
    ds_read_b64_tr_b16 v[38:39], v13 offset:25856
    s_waitcnt lgkmcnt(8)
    v_mfma_f32_32x32x16_bf16 v[16:31], v[52:55], v[212:215], v[16:31]
    ds_read_b64_tr_b16 v[40:41], v13 offset:26624
    ds_read_b64_tr_b16 v[42:43], v13 offset:26880
    s_waitcnt lgkmcnt(8)
    v_mfma_f32_32x32x16_bf16 v[16:31], v[56:59], v[216:219], v[16:31]
    ds_read_b64_tr_b16 v[44:45], v13 offset:27648
    ds_read_b64_tr_b16 v[46:47], v13 offset:27904
    ds_read_b128 v[76:79], v252
    s_waitcnt lgkmcnt(9)
    v_mfma_f32_32x32x16_bf16 v[16:31], v[60:63], v[220:223], v[16:31]
    s_waitcnt lgkmcnt(7)
    v_mfma_f32_32x32x16_bf16 v[16:31], v[32:35], v[224:227], v[16:31]
    s_waitcnt lgkmcnt(5)
    v_mfma_f32_32x32x16_bf16 v[16:31], v[36:39], v[228:231], v[16:31]
    v_mov_b64 v[192:193], v[160:161]
    v_mov_b64 v[194:195], v[160:161]
    v_mov_b64 v[196:197], v[160:161]
    s_waitcnt lgkmcnt(3)
    v_mfma_f32_32x32x16_bf16 v[16:31], v[40:43], v[232:235], v[16:31]
    v_mov_b64 v[198:199], v[160:161]
    v_mov_b64 v[208:209], v[160:161]
    v_mov_b64 v[210:211], v[160:161]
    s_waitcnt lgkmcnt(1)
    v_mfma_f32_32x32x16_bf16 v[16:31], v[44:47], v[236:239], v[16:31]
    v_mov_b64 v[212:213], v[160:161]
    v_mov_b64 v[214:215], v[160:161]
    s_waitcnt lgkmcnt(0)
    v_mfma_f32_32x32x16_bf16 v[16:31], v[76:79], v[72:75], v[16:31]
    s_nop 11
    v_pk_mul_f32 v[16:17], v[16:17], v[68:69]
    v_cvt_pk_bf16_f32 v104, v16, v17
    v_pk_mul_f32 v[18:19], v[18:19], v[68:69]
    v_cvt_pk_bf16_f32 v105, v18, v19
    v_pk_mul_f32 v[20:21], v[20:21], v[68:69]
    v_cvt_pk_bf16_f32 v106, v20, v21
    v_pk_mul_f32 v[22:23], v[22:23], v[68:69]
    v_cvt_pk_bf16_f32 v107, v22, v23
    v_cndmask_b32 v104, 0, v104, s[56:57]
    v_cndmask_b32 v105, 0, v105, s[56:57]
    ds_write_b128 v251, v[104:107]
    v_pk_mul_f32 v[24:25], v[24:25], v[68:69]
    v_cvt_pk_bf16_f32 v108, v24, v25
    v_pk_mul_f32 v[26:27], v[26:27], v[68:69]
    v_cvt_pk_bf16_f32 v109, v26, v27
    v_pk_mul_f32 v[28:29], v[28:29], v[68:69]
    v_cvt_pk_bf16_f32 v110, v28, v29
    v_pk_mul_f32 v[30:31], v[30:31], v[68:69]
    v_cvt_pk_bf16_f32 v111, v30, v31
    v_cndmask_b32 v110, 0, v110, s[34:35]
    v_cndmask_b32 v111, 0, v111, s[34:35]
    ds_write_b128 v251, v[108:111] offset:1024
    s_waitcnt lgkmcnt(0)
    s_barrier
    ds_read_b128 v[8:11], v244
    ds_read_b128 v[12:15], v244 offset:1024
    ds_read_b128 v[16:19], v245
    ds_read_b128 v[20:23], v245 offset:1024
    ds_read_b128 v[24:27], v246
    ds_read_b128 v[28:31], v246 offset:1024
    ds_read_b128 v[32:35], v247
    ds_read_b128 v[36:39], v247 offset:1024
    ds_write_b128 v1, v[240:243] offset:3072
    s_waitcnt lgkmcnt(0)
    s_load_dwordx4 s[80:83], s[76:77], 0 glc
    s_load_dwordx4 s[84:87], s[76:77], 32768 glc
    s_load_dwordx4 s[88:91], s[76:77], 65536 glc
    s_load_dwordx4 s[92:95], s[76:77], 98304 glc
    s_barrier
    v_mfma_f32_32x32x16_bf16 v[40:55], v[240:243], v[120:123], 0
    v_mfma_f32_32x32x16_bf16 v[56:71], v[240:243], v[120:123], 0
    v_mfma_f32_32x32x16_bf16 v[72:87], v[240:243], v[120:123], 0
    v_mfma_f32_32x32x16_bf16 v[88:103], v[240:243], v[120:123], 0
    s_waitcnt lgkmcnt(0)
    s_xor_b64 vcc, s[92:93], s[36:37]
    s_xor_b64 s[42:43], s[94:95], s[36:37]
    s_or_b64 vcc, vcc, s[42:43]
    s_addc_u32 s33, s33, s33
    s_xor_b64 vcc, s[88:89], s[36:37]
    s_xor_b64 s[42:43], s[90:91], s[36:37]
    s_or_b64 vcc, vcc, s[42:43]
    s_addc_u32 s33, s33, s33
    s_xor_b64 vcc, s[84:85], s[36:37]
    s_xor_b64 s[42:43], s[86:87], s[36:37]
    s_or_b64 vcc, vcc, s[42:43]
    s_addc_u32 s33, s33, s33
    s_xor_b64 vcc, s[80:81], s[36:37]
    s_xor_b64 s[42:43], s[82:83], s[36:37]
    s_or_b64 vcc, vcc, s[42:43]
    s_addc_u32 s33, s33, s33
    s_andn2_b32 s41, s70, s33
    s_cbranch_scc0 PK_20
PKD_21:
    s_ff1_i32_b32 s41, s41
    s_bitset0_b32 s70, s41
    s_lshl_b32 s42, s41, 15
    s_mul_i32 s41, s41, 458752
    s_add_u32 s42, s42, s98
    s_add_u32 s41, s41, s59
    buffer_load_dwordx4 v[152:155], v6, s[12:15], s41 offen offset:0 sc1
    buffer_load_dwordx4 v[156:159], v6, s[12:15], s41 offen offset:1024 sc1
    s_mov_b64 exec, s[52:53]
    buffer_load_dwordx4 v[160:163], v6, s[12:15], s42 offen offset:0 sc1
    buffer_load_dwordx4 v[164:167], v6, s[12:15], s42 offen offset:1024 sc1
    s_mov_b64 exec, -1
    s_andn2_b32 s41, s70, s33
    s_cbranch_scc0 PK_22
PKD_23:
    s_ff1_i32_b32 s41, s41
    s_bitset0_b32 s70, s41
    s_lshl_b32 s42, s41, 15
    s_mul_i32 s41, s41, 458752
    s_add_u32 s42, s42, s98
    s_add_u32 s41, s41, s59
    buffer_load_dwordx4 v[168:171], v6, s[12:15], s41 offen offset:0 sc1
    buffer_load_dwordx4 v[172:175], v6, s[12:15], s41 offen offset:1024 sc1
    s_mov_b64 exec, s[52:53]
    buffer_load_dwordx4 v[176:179], v6, s[12:15], s42 offen offset:0 sc1
    buffer_load_dwordx4 v[180:183], v6, s[12:15], s42 offen offset:1024 sc1
    s_mov_b64 exec, -1
    s_waitcnt vmcnt(6)
    v_mfma_f32_32x32x16_bf16 v[104:119], v[152:155], v[8:11], 0
    v_mfma_f32_32x32x16_bf16 v[104:119], v[156:159], v[12:15], v[104:119]
    s_setprio 3
    v_mfma_f32_32x32x16_bf16 v[120:135], v[152:155], v[16:19], 0
    s_nop 9
    v_exp_f32 v104, v104
    v_exp_f32 v105, v105
    v_exp_f32 v106, v106
    v_exp_f32 v107, v107
    v_mfma_f32_32x32x16_bf16 v[120:135], v[156:159], v[20:23], v[120:135]
    v_exp_f32 v108, v108
    v_exp_f32 v109, v109
    v_exp_f32 v110, v110
    v_exp_f32 v111, v111
    v_exp_f32 v112, v112
    v_exp_f32 v113, v113
    v_exp_f32 v114, v114
    v_exp_f32 v115, v115
    s_waitcnt vmcnt(4)
    v_smfmac_f32_32x32x32_bf16 v[40:55], v[160:163], v[104:111], v2
    v_exp_f32 v116, v116
    v_exp_f32 v117, v117
    v_exp_f32 v118, v118
    v_exp_f32 v119, v119
    v_mfma_f32_32x32x16_bf16 v[136:151], v[152:155], v[24:27], 0
    v_exp_f32 v120, v120
    v_exp_f32 v121, v121
    v_exp_f32 v122, v122
    v_exp_f32 v123, v123
    v_mfma_f32_32x32x16_bf16 v[136:151], v[156:159], v[28:31], v[136:151]
    v_exp_f32 v124, v124
    v_exp_f32 v125, v125
    v_exp_f32 v126, v126
    v_exp_f32 v127, v127
    v_smfmac_f32_32x32x32_bf16 v[40:55], v[164:167], v[112:119], v2
    v_exp_f32 v128, v128
    v_exp_f32 v129, v129
    v_exp_f32 v130, v130
    v_exp_f32 v131, v131
    v_smfmac_f32_32x32x32_bf16 v[56:71], v[160:163], v[120:127], v2
    v_exp_f32 v132, v132
    v_exp_f32 v133, v133
    v_exp_f32 v134, v134
    v_exp_f32 v135, v135
    v_mfma_f32_32x32x16_bf16 v[104:119], v[152:155], v[32:35], 0
    v_exp_f32 v136, v136
    v_exp_f32 v137, v137
    v_exp_f32 v138, v138
    v_exp_f32 v139, v139
    v_mfma_f32_32x32x16_bf16 v[104:119], v[156:159], v[36:39], v[104:119]
    v_exp_f32 v140, v140
    v_exp_f32 v141, v141
    v_exp_f32 v142, v142
    v_exp_f32 v143, v143
    v_smfmac_f32_32x32x32_bf16 v[56:71], v[164:167], v[128:135], v2
    s_andn2_b32 s41, s70, s33
    s_cbranch_scc0 PK_24
PKD_25:
    s_ff1_i32_b32 s41, s41
    s_bitset0_b32 s70, s41
    s_lshl_b32 s42, s41, 15
    s_mul_i32 s41, s41, 458752
    s_add_u32 s42, s42, s98
    s_add_u32 s41, s41, s59
    buffer_load_dwordx4 v[184:187], v6, s[12:15], s41 offen offset:0 sc1
    buffer_load_dwordx4 v[188:191], v6, s[12:15], s41 offen offset:1024 sc1
    s_mov_b64 exec, s[52:53]
    buffer_load_dwordx4 v[192:195], v6, s[12:15], s42 offen offset:0 sc1
    buffer_load_dwordx4 v[196:199], v6, s[12:15], s42 offen offset:1024 sc1
    s_mov_b64 exec, -1
    v_exp_f32 v144, v144
    v_exp_f32 v145, v145
    v_exp_f32 v146, v146
    v_exp_f32 v147, v147
    v_smfmac_f32_32x32x32_bf16 v[72:87], v[160:163], v[136:143], v2
    v_exp_f32 v148, v148
    v_exp_f32 v149, v149
    v_exp_f32 v150, v150
    v_exp_f32 v151, v151
    s_waitcnt vmcnt(6)
    v_mfma_f32_32x32x16_bf16 v[120:135], v[168:171], v[8:11], 0
    v_exp_f32 v104, v104
    v_exp_f32 v105, v105
    v_exp_f32 v106, v106
    v_exp_f32 v107, v107
    v_mfma_f32_32x32x16_bf16 v[120:135], v[172:175], v[12:15], v[120:135]
    v_exp_f32 v108, v108
    v_exp_f32 v109, v109
    v_exp_f32 v110, v110
    v_exp_f32 v111, v111
    v_smfmac_f32_32x32x32_bf16 v[72:87], v[164:167], v[144:151], v2
    v_exp_f32 v112, v112
    v_exp_f32 v113, v113
    v_exp_f32 v114, v114
    v_exp_f32 v115, v115
    v_smfmac_f32_32x32x32_bf16 v[88:103], v[160:163], v[104:111], v2
    v_exp_f32 v116, v116
    v_exp_f32 v117, v117
    v_exp_f32 v118, v118
    v_exp_f32 v119, v119
    v_mfma_f32_32x32x16_bf16 v[136:151], v[168:171], v[16:19], 0
    v_exp_f32 v120, v120
    v_exp_f32 v121, v121
    v_exp_f32 v122, v122
    v_exp_f32 v123, v123
    v_mfma_f32_32x32x16_bf16 v[136:151], v[172:175], v[20:23], v[136:151]
    v_exp_f32 v124, v124
    v_exp_f32 v125, v125
    v_exp_f32 v126, v126
    v_exp_f32 v127, v127
    v_smfmac_f32_32x32x32_bf16 v[88:103], v[164:167], v[112:119], v2
    s_andn2_b32 s41, s70, s33
    s_cbranch_scc0 PK_26
PKD_27:
    s_ff1_i32_b32 s41, s41
    s_bitset0_b32 s70, s41
    s_lshl_b32 s42, s41, 15
    s_mul_i32 s41, s41, 458752
    s_add_u32 s42, s42, s98
    s_add_u32 s41, s41, s59
    buffer_load_dwordx4 v[200:203], v6, s[12:15], s41 offen offset:0 sc1
    buffer_load_dwordx4 v[204:207], v6, s[12:15], s41 offen offset:1024 sc1
    s_mov_b64 exec, s[52:53]
    buffer_load_dwordx4 v[208:211], v6, s[12:15], s42 offen offset:0 sc1
    buffer_load_dwordx4 v[212:215], v6, s[12:15], s42 offen offset:1024 sc1
    s_mov_b64 exec, -1
    v_exp_f32 v128, v128
    v_exp_f32 v129, v129
    v_exp_f32 v130, v130
    v_exp_f32 v131, v131
    s_waitcnt vmcnt(8)
    v_smfmac_f32_32x32x32_bf16 v[40:55], v[176:179], v[120:127], v2
    v_exp_f32 v132, v132
    v_exp_f32 v133, v133
    v_exp_f32 v134, v134
    v_exp_f32 v135, v135
    v_mfma_f32_32x32x16_bf16 v[104:119], v[168:171], v[24:27], 0
    v_exp_f32 v136, v136
    v_exp_f32 v137, v137
    v_exp_f32 v138, v138
    v_exp_f32 v139, v139
    v_mfma_f32_32x32x16_bf16 v[104:119], v[172:175], v[28:31], v[104:119]
    v_exp_f32 v140, v140
    v_exp_f32 v141, v141
    v_exp_f32 v142, v142
    v_exp_f32 v143, v143
    v_smfmac_f32_32x32x32_bf16 v[40:55], v[180:183], v[128:135], v2
    s_load_dwordx4 s[80:83], s[76:77], 4096 glc
    s_load_dwordx4 s[84:87], s[76:77], 36864 glc
    s_load_dwordx4 s[88:91], s[76:77], 69632 glc
    s_load_dwordx4 s[92:95], s[76:77], 102400 glc
    v_exp_f32 v144, v144
    v_exp_f32 v145, v145
    v_exp_f32 v146, v146
    v_exp_f32 v147, v147
    v_smfmac_f32_32x32x32_bf16 v[56:71], v[176:179], v[136:143], v2
    v_exp_f32 v148, v148
    v_exp_f32 v149, v149
    v_exp_f32 v150, v150
    v_exp_f32 v151, v151
    v_mfma_f32_32x32x16_bf16 v[120:135], v[168:171], v[32:35], 0
    v_exp_f32 v104, v104
    v_exp_f32 v105, v105
    v_exp_f32 v106, v106
    v_exp_f32 v107, v107
    v_mfma_f32_32x32x16_bf16 v[120:135], v[172:175], v[36:39], v[120:135]
    v_exp_f32 v108, v108
    v_exp_f32 v109, v109
    v_exp_f32 v110, v110
    v_exp_f32 v111, v111
    v_smfmac_f32_32x32x32_bf16 v[56:71], v[180:183], v[144:151], v2
    v_exp_f32 v112, v112
    v_exp_f32 v113, v113
    v_exp_f32 v114, v114
    v_exp_f32 v115, v115
    v_smfmac_f32_32x32x32_bf16 v[72:87], v[176:179], v[104:111], v2
    v_exp_f32 v116, v116
    v_exp_f32 v117, v117
    v_exp_f32 v118, v118
    v_exp_f32 v119, v119
    s_waitcnt vmcnt(6)
    v_mfma_f32_32x32x16_bf16 v[136:151], v[184:187], v[8:11], 0
    v_exp_f32 v120, v120
    v_exp_f32 v121, v121
    v_exp_f32 v122, v122
    v_exp_f32 v123, v123
    v_mfma_f32_32x32x16_bf16 v[136:151], v[188:191], v[12:15], v[136:151]
    v_exp_f32 v124, v124
    v_exp_f32 v125, v125
    v_exp_f32 v126, v126
    v_exp_f32 v127, v127
    v_smfmac_f32_32x32x32_bf16 v[72:87], v[180:183], v[112:119], v2
    v_exp_f32 v128, v128
    v_exp_f32 v129, v129
    v_exp_f32 v130, v130
    v_exp_f32 v131, v131
    v_smfmac_f32_32x32x32_bf16 v[88:103], v[176:179], v[120:127], v2
    v_exp_f32 v132, v132
    v_exp_f32 v133, v133
    v_exp_f32 v134, v134
    v_exp_f32 v135, v135
    v_mfma_f32_32x32x16_bf16 v[104:119], v[184:187], v[16:19], 0
    v_exp_f32 v136, v136
    v_exp_f32 v137, v137
    v_exp_f32 v138, v138
    v_exp_f32 v139, v139
    v_mfma_f32_32x32x16_bf16 v[104:119], v[188:191], v[20:23], v[104:119]
    v_exp_f32 v140, v140
    v_exp_f32 v141, v141
    v_exp_f32 v142, v142
    v_exp_f32 v143, v143
    v_smfmac_f32_32x32x32_bf16 v[88:103], v[180:183], v[128:135], v2
    s_waitcnt lgkmcnt(0)
    s_xor_b64 vcc, s[92:93], s[36:37]
    s_xor_b64 s[42:43], s[94:95], s[36:37]
    s_or_b64 vcc, vcc, s[42:43]
    s_addc_u32 s33, s33, s33
    s_xor_b64 vcc, s[88:89], s[36:37]
    s_xor_b64 s[42:43], s[90:91], s[36:37]
    s_or_b64 vcc, vcc, s[42:43]
    s_addc_u32 s33, s33, s33
    s_xor_b64 vcc, s[84:85], s[36:37]
    s_xor_b64 s[42:43], s[86:87], s[36:37]
    s_or_b64 vcc, vcc, s[42:43]
    s_addc_u32 s33, s33, s33
    s_xor_b64 vcc, s[80:81], s[36:37]
    s_xor_b64 s[42:43], s[82:83], s[36:37]
    s_or_b64 vcc, vcc, s[42:43]
    s_addc_u32 s33, s33, s33
    s_mov_b32 s70, 15
    s_andn2_b32 s41, s70, s33
    s_cbranch_scc0 PK_28
PKD_29:
    s_ff1_i32_b32 s41, s41
    s_bitset0_b32 s70, s41
    s_lshl_b32 s42, s41, 15
    s_mul_i32 s41, s41, 458752
    s_add_u32 s98, s98, 4096
    s_add_u32 s59, s59, 57344
    s_add_u32 s42, s42, s98
    s_add_u32 s41, s41, s59
    buffer_load_dwordx4 v[152:155], v6, s[12:15], s41 offen offset:0 sc1
    buffer_load_dwordx4 v[156:159], v6, s[12:15], s41 offen offset:1024 sc1
    s_mov_b64 exec, s[52:53]
    buffer_load_dwordx4 v[160:163], v6, s[12:15], s42 offen offset:0 sc1
    buffer_load_dwordx4 v[164:167], v6, s[12:15], s42 offen offset:1024 sc1
    s_mov_b64 exec, -1
    v_lshrrev_b32 v1, 2, v0
    v_mul_u32_u24 v1, 3584, v1
    v_and_or_b32 v1, v6, 48, v1
    s_and_b32 s43, s40, 3
    s_lshl_b32 s42, s43, 10
    s_add_u32 m0, s42, 135168
    s_mul_i32 s41, s43, 57344
    s_add_u32 s41, s41, s100
    buffer_load_dwordx4 v1, s[24:27], s41 offen  lds
    s_add_u32 s43, s43, 4
    s_lshl_b32 s42, s43, 10
    s_add_u32 m0, s42, 135168
    s_mul_i32 s41, s43, 57344
    s_add_u32 s41, s41, s100
    buffer_load_dwordx4 v1, s[24:27], s41 offen  lds
    s_add_u32 s43, s43, 4
    s_lshl_b32 s42, s43, 10
    s_add_u32 m0, s42, 135168
    s_mul_i32 s41, s43, 57344
    s_add_u32 s41, s41, s100
    buffer_load_dwordx4 v1, s[24:27], s41 offen  lds
    s_add_u32 s43, s43, 4
    s_min_u32 s43, s43, 13
    s_lshl_b32 s42, s43, 10
    s_add_u32 m0, s42, 135168
    s_mul_i32 s41, s43, 57344
    s_add_u32 s41, s41, s100
    buffer_load_dwordx4 v1, s[24:27], s41 offen  lds
    v_exp_f32 v144, v144
    v_exp_f32 v145, v145
    v_exp_f32 v146, v146
    v_exp_f32 v147, v147
    s_waitcnt vmcnt(12)
    v_smfmac_f32_32x32x32_bf16 v[40:55], v[192:195], v[136:143], v2
    v_exp_f32 v148, v148
    v_exp_f32 v149, v149
    v_exp_f32 v150, v150
    v_exp_f32 v151, v151
    v_mfma_f32_32x32x16_bf16 v[120:135], v[184:187], v[24:27], 0
    v_exp_f32 v104, v104
    v_exp_f32 v105, v105
    v_exp_f32 v106, v106
    v_exp_f32 v107, v107
    v_mfma_f32_32x32x16_bf16 v[120:135], v[188:191], v[28:31], v[120:135]
    v_exp_f32 v108, v108
    v_exp_f32 v109, v109
    v_exp_f32 v110, v110
    v_exp_f32 v111, v111
    v_smfmac_f32_32x32x32_bf16 v[40:55], v[196:199], v[144:151], v2
    v_exp_f32 v112, v112
    v_exp_f32 v113, v113
    v_exp_f32 v114, v114
    v_exp_f32 v115, v115
    v_smfmac_f32_32x32x32_bf16 v[56:71], v[192:195], v[104:111], v2
    v_exp_f32 v116, v116
    v_exp_f32 v117, v117
    v_exp_f32 v118, v118
    v_exp_f32 v119, v119
    v_mfma_f32_32x32x16_bf16 v[136:151], v[184:187], v[32:35], 0
    v_exp_f32 v120, v120
    v_exp_f32 v121, v121
    v_exp_f32 v122, v122
    v_exp_f32 v123, v123
    v_mfma_f32_32x32x16_bf16 v[136:151], v[188:191], v[36:39], v[136:151]
    v_exp_f32 v124, v124
    v_exp_f32 v125, v125
    v_exp_f32 v126, v126
    v_exp_f32 v127, v127
    v_smfmac_f32_32x32x32_bf16 v[56:71], v[196:199], v[112:119], v2
    v_exp_f32 v128, v128
    v_exp_f32 v129, v129
    v_exp_f32 v130, v130
    v_exp_f32 v131, v131
    v_smfmac_f32_32x32x32_bf16 v[72:87], v[192:195], v[120:127], v2
    v_exp_f32 v132, v132
    v_exp_f32 v133, v133
    v_exp_f32 v134, v134
    v_exp_f32 v135, v135
    s_waitcnt vmcnt(10)
    v_mfma_f32_32x32x16_bf16 v[104:119], v[200:203], v[8:11], 0
    v_exp_f32 v136, v136
    v_exp_f32 v137, v137
    v_exp_f32 v138, v138
    v_exp_f32 v139, v139
    v_mfma_f32_32x32x16_bf16 v[104:119], v[204:207], v[12:15], v[104:119]
    v_exp_f32 v140, v140
    v_exp_f32 v141, v141
    v_exp_f32 v142, v142
    v_exp_f32 v143, v143
    v_smfmac_f32_32x32x32_bf16 v[72:87], v[196:199], v[128:135], v2
    v_exp_f32 v144, v144
    v_exp_f32 v145, v145
    v_exp_f32 v146, v146
    v_exp_f32 v147, v147
    v_smfmac_f32_32x32x32_bf16 v[88:103], v[192:195], v[136:143], v2
    v_exp_f32 v148, v148
    v_exp_f32 v149, v149
    v_exp_f32 v150, v150
    v_exp_f32 v151, v151
    v_mfma_f32_32x32x16_bf16 v[120:135], v[200:203], v[16:19], 0
    v_exp_f32 v104, v104
    v_exp_f32 v105, v105
    v_exp_f32 v106, v106
    v_exp_f32 v107, v107
    v_mfma_f32_32x32x16_bf16 v[120:135], v[204:207], v[20:23], v[120:135]
    v_exp_f32 v108, v108
    v_exp_f32 v109, v109
    v_exp_f32 v110, v110
    v_exp_f32 v111, v111
    v_smfmac_f32_32x32x32_bf16 v[88:103], v[196:199], v[144:151], v2
    v_exp_f32 v112, v112
    v_exp_f32 v113, v113
    v_exp_f32 v114, v114
    v_exp_f32 v115, v115
    s_waitcnt vmcnt(8)
    v_smfmac_f32_32x32x32_bf16 v[40:55], v[208:211], v[104:111], v2
    v_exp_f32 v116, v116
    v_exp_f32 v117, v117
    v_exp_f32 v118, v118
    v_exp_f32 v119, v119
    v_mfma_f32_32x32x16_bf16 v[136:151], v[200:203], v[24:27], 0
    v_exp_f32 v120, v120
    v_exp_f32 v121, v121
    v_exp_f32 v122, v122
    v_exp_f32 v123, v123
    v_mfma_f32_32x32x16_bf16 v[136:151], v[204:207], v[28:31], v[136:151]
    v_exp_f32 v124, v124
    v_exp_f32 v125, v125
    v_exp_f32 v126, v126
    v_exp_f32 v127, v127
    v_smfmac_f32_32x32x32_bf16 v[40:55], v[212:215], v[112:119], v2
    v_exp_f32 v128, v128
    v_exp_f32 v129, v129
    v_exp_f32 v130, v130
    v_exp_f32 v131, v131
    v_smfmac_f32_32x32x32_bf16 v[56:71], v[208:211], v[120:127], v2
    v_exp_f32 v132, v132
    v_exp_f32 v133, v133
    v_exp_f32 v134, v134
    v_exp_f32 v135, v135
    v_mfma_f32_32x32x16_bf16 v[104:119], v[200:203], v[32:35], 0
    v_exp_f32 v136, v136
    v_exp_f32 v137, v137
    v_exp_f32 v138, v138
    v_exp_f32 v139, v139
    v_mfma_f32_32x32x16_bf16 v[104:119], v[204:207], v[36:39], v[104:119]
    v_exp_f32 v140, v140
    v_exp_f32 v141, v141
    v_exp_f32 v142, v142
    v_exp_f32 v143, v143
    v_smfmac_f32_32x32x32_bf16 v[56:71], v[212:215], v[128:135], v2
    v_exp_f32 v144, v144
    v_exp_f32 v145, v145
    v_exp_f32 v146, v146
    v_exp_f32 v147, v147
    v_smfmac_f32_32x32x32_bf16 v[72:87], v[208:211], v[136:143], v2
    v_exp_f32 v148, v148
    v_exp_f32 v149, v149
    v_exp_f32 v150, v150
    v_exp_f32 v151, v151
    s_waitcnt vmcnt(6)
    v_mfma_f32_32x32x16_bf16 v[120:135], v[152:155], v[8:11], 0
    v_exp_f32 v104, v104
    v_exp_f32 v105, v105
    v_exp_f32 v106, v106
    v_exp_f32 v107, v107
    v_mfma_f32_32x32x16_bf16 v[120:135], v[156:159], v[12:15], v[120:135]
    v_exp_f32 v108, v108
    v_exp_f32 v109, v109
    v_exp_f32 v110, v110
    v_exp_f32 v111, v111
    v_smfmac_f32_32x32x32_bf16 v[72:87], v[212:215], v[144:151], v2
    v_exp_f32 v112, v112
    v_exp_f32 v113, v113
    v_exp_f32 v114, v114
    v_exp_f32 v115, v115
    v_smfmac_f32_32x32x32_bf16 v[88:103], v[208:211], v[104:111], v2
    v_exp_f32 v116, v116
    v_exp_f32 v117, v117
    v_exp_f32 v118, v118
    v_exp_f32 v119, v119
    s_setprio 2
    v_mfma_f32_32x32x16_bf16 v[136:151], v[152:155], v[16:19], 0
    v_exp_f32 v120, v120
    v_exp_f32 v121, v121
    v_exp_f32 v122, v122
    v_exp_f32 v123, v123
    v_mfma_f32_32x32x16_bf16 v[136:151], v[156:159], v[20:23], v[136:151]
    v_exp_f32 v124, v124
    v_exp_f32 v125, v125
    v_exp_f32 v126, v126
    v_exp_f32 v127, v127
    v_smfmac_f32_32x32x32_bf16 v[88:103], v[212:215], v[112:119], v2
    s_andn2_b32 s41, s70, s33
    s_cbranch_scc0 PK_30
PKD_31:
    s_ff1_i32_b32 s41, s41
    s_bitset0_b32 s70, s41
    s_lshl_b32 s42, s41, 15
    s_mul_i32 s41, s41, 458752
    s_add_u32 s42, s42, s98
    s_add_u32 s41, s41, s59
    buffer_load_dwordx4 v[168:171], v6, s[12:15], s41 offen offset:0 sc1
    buffer_load_dwordx4 v[172:175], v6, s[12:15], s41 offen offset:1024 sc1
    s_mov_b64 exec, s[52:53]
    buffer_load_dwordx4 v[176:179], v6, s[12:15], s42 offen offset:0 sc1
    buffer_load_dwordx4 v[180:183], v6, s[12:15], s42 offen offset:1024 sc1
    s_mov_b64 exec, -1
    v_exp_f32 v128, v128
    v_exp_f32 v129, v129
    v_exp_f32 v130, v130
    v_exp_f32 v131, v131
    s_waitcnt vmcnt(8)
    v_smfmac_f32_32x32x32_bf16 v[40:55], v[160:163], v[120:127], v2
    v_exp_f32 v132, v132
    v_exp_f32 v133, v133
    v_exp_f32 v134, v134
    v_exp_f32 v135, v135
    v_mfma_f32_32x32x16_bf16 v[104:119], v[152:155], v[24:27], 0
    v_exp_f32 v136, v136
    v_exp_f32 v137, v137
    v_exp_f32 v138, v138
    v_exp_f32 v139, v139
    v_mfma_f32_32x32x16_bf16 v[104:119], v[156:159], v[28:31], v[104:119]
    v_exp_f32 v140, v140
    v_exp_f32 v141, v141
    v_exp_f32 v142, v142
    v_exp_f32 v143, v143
    v_smfmac_f32_32x32x32_bf16 v[40:55], v[164:167], v[128:135], v2
    s_andn2_b32 s41, s70, s33
    s_cbranch_scc0 PK_32
PKD_33:
    s_ff1_i32_b32 s41, s41
    s_bitset0_b32 s70, s41
    s_lshl_b32 s42, s41, 15
    s_mul_i32 s41, s41, 458752
    s_add_u32 s42, s42, s98
    s_add_u32 s41, s41, s59
    buffer_load_dwordx4 v[184:187], v6, s[12:15], s41 offen offset:0 sc1
    buffer_load_dwordx4 v[188:191], v6, s[12:15], s41 offen offset:1024 sc1
    s_mov_b64 exec, s[52:53]
    buffer_load_dwordx4 v[192:195], v6, s[12:15], s42 offen offset:0 sc1
    buffer_load_dwordx4 v[196:199], v6, s[12:15], s42 offen offset:1024 sc1
    s_mov_b64 exec, -1
    s_and_b32 s41, s40, 3
    s_lshl2_add_u32 s41, s41, 157760
    v_mov_b32 v1, s41
    s_waitcnt vmcnt(8)
    ds_write_b32 v1, v2
    v_exp_f32 v144, v144
    v_exp_f32 v145, v145
    v_exp_f32 v146, v146
    v_exp_f32 v147, v147
    v_smfmac_f32_32x32x32_bf16 v[56:71], v[160:163], v[136:143], v2
    v_exp_f32 v148, v148
    v_exp_f32 v149, v149
    v_exp_f32 v150, v150
    v_exp_f32 v151, v151
    v_mfma_f32_32x32x16_bf16 v[120:135], v[152:155], v[32:35], 0
    v_exp_f32 v104, v104
    v_exp_f32 v105, v105
    v_exp_f32 v106, v106
    v_exp_f32 v107, v107
    v_mfma_f32_32x32x16_bf16 v[120:135], v[156:159], v[36:39], v[120:135]
    v_exp_f32 v108, v108
    v_exp_f32 v109, v109
    v_exp_f32 v110, v110
    v_exp_f32 v111, v111
    v_smfmac_f32_32x32x32_bf16 v[56:71], v[164:167], v[144:151], v2
    s_andn2_b32 s41, s70, s33
    s_cbranch_scc0 PK_34
PKD_35:
    s_ff1_i32_b32 s41, s41
    s_bitset0_b32 s70, s41
    s_lshl_b32 s42, s41, 15
    s_mul_i32 s41, s41, 458752
    s_add_u32 s42, s42, s98
    s_add_u32 s41, s41, s59
    buffer_load_dwordx4 v[200:203], v6, s[12:15], s41 offen offset:0 sc1
    buffer_load_dwordx4 v[204:207], v6, s[12:15], s41 offen offset:1024 sc1
    s_mov_b64 exec, s[52:53]
    buffer_load_dwordx4 v[208:211], v6, s[12:15], s42 offen offset:0 sc1
    buffer_load_dwordx4 v[212:215], v6, s[12:15], s42 offen offset:1024 sc1
    s_mov_b64 exec, -1
    v_exp_f32 v112, v112
    v_exp_f32 v113, v113
    v_exp_f32 v114, v114
    v_exp_f32 v115, v115
    v_smfmac_f32_32x32x32_bf16 v[72:87], v[160:163], v[104:111], v2
    v_exp_f32 v116, v116
    v_exp_f32 v117, v117
    v_exp_f32 v118, v118
    v_exp_f32 v119, v119
    s_waitcnt vmcnt(10)
    v_mfma_f32_32x32x16_bf16 v[136:151], v[168:171], v[8:11], 0
    v_exp_f32 v120, v120
    v_exp_f32 v121, v121
    v_exp_f32 v122, v122
    v_exp_f32 v123, v123
    v_mfma_f32_32x32x16_bf16 v[136:151], v[172:175], v[12:15], v[136:151]
    v_exp_f32 v124, v124
    v_exp_f32 v125, v125
    v_exp_f32 v126, v126
    v_exp_f32 v127, v127
    v_smfmac_f32_32x32x32_bf16 v[72:87], v[164:167], v[112:119], v2
    v_exp_f32 v128, v128
    v_exp_f32 v129, v129
    v_exp_f32 v130, v130
    v_exp_f32 v131, v131
    v_smfmac_f32_32x32x32_bf16 v[88:103], v[160:163], v[120:127], v2
    v_exp_f32 v132, v132
    v_exp_f32 v133, v133
    v_exp_f32 v134, v134
    v_exp_f32 v135, v135
    s_waitcnt vmcnt(6)
    v_mfma_f32_32x32x16_bf16 v[104:119], v[184:187], v[8:11], 0
    v_exp_f32 v136, v136
    v_exp_f32 v137, v137
    v_exp_f32 v138, v138
    v_exp_f32 v139, v139
    v_mfma_f32_32x32x16_bf16 v[104:119], v[188:191], v[12:15], v[104:119]
    v_exp_f32 v140, v140
    v_exp_f32 v141, v141
    v_exp_f32 v142, v142
    v_exp_f32 v143, v143
    v_smfmac_f32_32x32x32_bf16 v[88:103], v[164:167], v[128:135], v2
    v_exp_f32 v144, v144
    v_exp_f32 v145, v145
    v_exp_f32 v146, v146
    v_exp_f32 v147, v147
    s_waitcnt vmcnt(8)
    v_smfmac_f32_32x32x32_bf16 v[40:55], v[176:179], v[136:143], v2
    v_exp_f32 v148, v148
    v_exp_f32 v149, v149
    v_exp_f32 v150, v150
    v_exp_f32 v151, v151
    s_waitcnt vmcnt(2)
    v_mfma_f32_32x32x16_bf16 v[120:135], v[200:203], v[8:11], 0
    v_exp_f32 v104, v104
    v_exp_f32 v105, v105
    v_exp_f32 v106, v106
    v_exp_f32 v107, v107
    v_mfma_f32_32x32x16_bf16 v[120:135], v[204:207], v[12:15], v[120:135]
    v_exp_f32 v108, v108
    v_exp_f32 v109, v109
    v_exp_f32 v110, v110
    v_exp_f32 v111, v111
    v_smfmac_f32_32x32x32_bf16 v[40:55], v[180:183], v[144:151], v2
    v_exp_f32 v112, v112
    v_exp_f32 v113, v113
    v_exp_f32 v114, v114
    v_exp_f32 v115, v115
    s_waitcnt vmcnt(4)
    v_smfmac_f32_32x32x32_bf16 v[40:55], v[192:195], v[104:111], v2
    v_exp_f32 v116, v116
    v_exp_f32 v117, v117
    v_exp_f32 v118, v118
    v_exp_f32 v119, v119
    s_setprio 0
    v_mfma_f32_32x32x16_bf16 v[136:151], v[168:171], v[16:19], 0
    v_exp_f32 v120, v120
    v_exp_f32 v121, v121
    v_exp_f32 v122, v122
    v_exp_f32 v123, v123
    v_mfma_f32_32x32x16_bf16 v[136:151], v[172:175], v[20:23], v[136:151]
    v_exp_f32 v124, v124
    v_exp_f32 v125, v125
    v_exp_f32 v126, v126
    v_exp_f32 v127, v127
    v_smfmac_f32_32x32x32_bf16 v[40:55], v[196:199], v[112:119], v2
    s_mov_b64 exec, s[72:73]
    s_add_u32 m0, s78, s79
    s_lshl2_add_u32 s41, s79, s99
    buffer_load_dwordx4 v253, s[16:19], s41 offen lds
    s_add_u32 s41, s41, 2688
    buffer_load_dwordx4 v253, s[16:19], s41 offen offset:896 lds
    s_add_u32 s79, s79, 1792
    s_cmp_lt_u32 s79, 12544
    s_cselect_b32 s79, s79, 0
    s_mov_b64 exec, -1
    v_exp_f32 v128, v128
    v_exp_f32 v129, v129
    v_exp_f32 v130, v130
    v_exp_f32 v131, v131
    s_waitcnt vmcnt(2)
    v_smfmac_f32_32x32x32_bf16 v[40:55], v[208:211], v[120:127], v2
    v_exp_f32 v132, v132
    v_exp_f32 v133, v133
    v_exp_f32 v134, v134
    v_exp_f32 v135, v135
    v_mfma_f32_32x32x16_bf16 v[104:119], v[184:187], v[16:19], 0
    v_exp_f32 v136, v136
    v_exp_f32 v137, v137
    v_exp_f32 v138, v138
    v_exp_f32 v139, v139
    v_mfma_f32_32x32x16_bf16 v[104:119], v[188:191], v[20:23], v[104:119]
    v_exp_f32 v140, v140
    v_exp_f32 v141, v141
    v_exp_f32 v142, v142
    v_exp_f32 v143, v143
    v_smfmac_f32_32x32x32_bf16 v[40:55], v[212:215], v[128:135], v2
    s_mov_b64 exec, s[72:73]
    s_add_u32 m0, s78, s79
    s_lshl2_add_u32 s41, s79, s99
    buffer_load_dwordx4 v253, s[16:19], s41 offen lds
    s_add_u32 s41, s41, 2688
    buffer_load_dwordx4 v253, s[16:19], s41 offen offset:896 lds
    s_add_u32 s79, s79, 1792
    s_cmp_lt_u32 s79, 12544
    s_cselect_b32 s79, s79, 0
    s_mov_b64 exec, -1
    v_exp_f32 v144, v144
    v_exp_f32 v145, v145
    v_exp_f32 v146, v146
    v_exp_f32 v147, v147
    v_smfmac_f32_32x32x32_bf16 v[56:71], v[176:179], v[136:143], v2
    v_exp_f32 v148, v148
    v_exp_f32 v149, v149
    v_exp_f32 v150, v150
    v_exp_f32 v151, v151
    s_setprio 1
    v_mfma_f32_32x32x16_bf16 v[120:135], v[200:203], v[16:19], 0
    v_exp_f32 v104, v104
    v_exp_f32 v105, v105
    v_exp_f32 v106, v106
    v_exp_f32 v107, v107
    v_add_u32 v232, s65, v6
    ds_write_b128 v232, v[40:43] offset:0
    v_mfma_f32_32x32x16_bf16 v[120:135], v[204:207], v[20:23], v[120:135]
    v_exp_f32 v108, v108
    v_exp_f32 v109, v109
    v_exp_f32 v110, v110
    v_exp_f32 v111, v111
    ds_write_b128 v232, v[44:47] offset:1024
    v_smfmac_f32_32x32x32_bf16 v[56:71], v[180:183], v[144:151], v2
    s_mov_b64 exec, s[72:73]
    s_add_u32 m0, s78, s79
    s_lshl2_add_u32 s41, s79, s99
    buffer_load_dwordx4 v253, s[16:19], s41 offen lds
    s_add_u32 s41, s41, 2688
    buffer_load_dwordx4 v253, s[16:19], s41 offen offset:896 lds
    s_add_u32 s79, s79, 1792
    s_cmp_lt_u32 s79, 12544
    s_cselect_b32 s79, s79, 0
    s_mov_b64 exec, -1
    v_exp_f32 v112, v112
    v_exp_f32 v113, v113
    v_exp_f32 v114, v114
    v_exp_f32 v115, v115
    ds_write_b128 v232, v[48:51] offset:2048
    v_smfmac_f32_32x32x32_bf16 v[56:71], v[192:195], v[104:111], v2
    v_exp_f32 v116, v116
    v_exp_f32 v117, v117
    v_exp_f32 v118, v118
    v_exp_f32 v119, v119
    ds_write_b128 v232, v[52:55] offset:3072
    s_setprio 0
    v_mfma_f32_32x32x16_bf16 v[136:151], v[168:171], v[24:27], 0
    v_exp_f32 v120, v120
    v_exp_f32 v121, v121
    v_exp_f32 v122, v122
    v_exp_f32 v123, v123
    v_mfma_f32_32x32x16_bf16 v[136:151], v[172:175], v[28:31], v[136:151]
    v_exp_f32 v124, v124
    v_exp_f32 v125, v125
    v_exp_f32 v126, v126
    v_exp_f32 v127, v127
    v_smfmac_f32_32x32x32_bf16 v[56:71], v[196:199], v[112:119], v2
    s_mov_b64 exec, s[72:73]
    s_add_u32 m0, s78, s79
    s_lshl2_add_u32 s41, s79, s99
    buffer_load_dwordx4 v253, s[16:19], s41 offen lds
    s_add_u32 s41, s41, 2688
    buffer_load_dwordx4 v253, s[16:19], s41 offen offset:896 lds
    s_add_u32 s79, s79, 1792
    s_cmp_lt_u32 s79, 12544
    s_cselect_b32 s79, s79, 0
    s_mov_b64 exec, -1
    v_exp_f32 v128, v128
    v_exp_f32 v129, v129
    v_exp_f32 v130, v130
    v_exp_f32 v131, v131
    v_smfmac_f32_32x32x32_bf16 v[56:71], v[208:211], v[120:127], v2
    v_exp_f32 v132, v132
    v_exp_f32 v133, v133
    v_exp_f32 v134, v134
    v_exp_f32 v135, v135
    v_mfma_f32_32x32x16_bf16 v[104:119], v[184:187], v[24:27], 0
    v_exp_f32 v136, v136
    v_exp_f32 v137, v137
    v_exp_f32 v138, v138
    v_exp_f32 v139, v139
    v_mfma_f32_32x32x16_bf16 v[104:119], v[188:191], v[28:31], v[104:119]
    v_exp_f32 v140, v140
    v_exp_f32 v141, v141
    v_exp_f32 v142, v142
    v_exp_f32 v143, v143
    v_smfmac_f32_32x32x32_bf16 v[56:71], v[212:215], v[128:135], v2
    s_mov_b64 exec, s[72:73]
    s_add_u32 m0, s78, s79
    s_lshl2_add_u32 s41, s79, s99
    buffer_load_dwordx4 v253, s[16:19], s41 offen lds
    s_add_u32 s41, s41, 2688
    buffer_load_dwordx4 v253, s[16:19], s41 offen offset:896 lds
    s_add_u32 s79, s79, 1792
    s_cmp_lt_u32 s79, 12544
    s_cselect_b32 s79, s79, 0
    s_mov_b64 exec, -1
    v_add_u32 v232, s66, v6
    ds_read_b128 v[228:231], v232 offset:3072
    ds_read_b128 v[216:219], v232 offset:0
    ds_read_b128 v[220:223], v232 offset:1024
    ds_read_b128 v[224:227], v232 offset:2048
    v_exp_f32 v144, v144
    v_exp_f32 v145, v145
    v_exp_f32 v146, v146
    v_exp_f32 v147, v147
    v_smfmac_f32_32x32x32_bf16 v[72:87], v[176:179], v[136:143], v2
    v_exp_f32 v148, v148
    v_exp_f32 v149, v149
    v_exp_f32 v150, v150
    v_exp_f32 v151, v151
    s_setprio 1
    v_mfma_f32_32x32x16_bf16 v[120:135], v[200:203], v[24:27], 0
    v_exp_f32 v104, v104
    v_exp_f32 v105, v105
    v_exp_f32 v106, v106
    v_exp_f32 v107, v107
    s_waitcnt lgkmcnt(0)
    v_cmp_gt_f32 vcc, 0.5, v231
    s_nop 0
    s_andn2_b64 vcc, vcc, s[54:55]
    s_cbranch_vccnz RETRY_36
OK_38:
    v_pk_add_f32 v[56:57], v[56:57], v[216:217]
    v_pk_add_f32 v[58:59], v[58:59], v[218:219]
    v_pk_add_f32 v[60:61], v[60:61], v[220:221]
    v_pk_add_f32 v[62:63], v[62:63], v[222:223]
    v_pk_add_f32 v[64:65], v[64:65], v[224:225]
    v_pk_add_f32 v[66:67], v[66:67], v[226:227]
    v_pk_add_f32 v[68:69], v[68:69], v[228:229]
    v_pk_add_f32 v[70:71], v[70:71], v[230:231]
    ds_write_b128 v232, v[56:59] offset:0
    v_mfma_f32_32x32x16_bf16 v[120:135], v[204:207], v[28:31], v[120:135]
    v_exp_f32 v108, v108
    v_exp_f32 v109, v109
    v_exp_f32 v110, v110
    v_exp_f32 v111, v111
    ds_write_b128 v232, v[60:63] offset:1024
    v_smfmac_f32_32x32x32_bf16 v[72:87], v[180:183], v[144:151], v2
    s_mov_b64 exec, s[72:73]
    s_add_u32 m0, s78, s79
    s_lshl2_add_u32 s41, s79, s99
    buffer_load_dwordx4 v253, s[16:19], s41 offen lds
    s_add_u32 s41, s41, 2688
    buffer_load_dwordx4 v253, s[16:19], s41 offen offset:896 lds
    s_add_u32 s79, s79, 1792
    s_cmp_lt_u32 s79, 12544
    s_cselect_b32 s79, s79, 0
    s_mov_b64 exec, -1
    v_exp_f32 v112, v112
    v_exp_f32 v113, v113
    v_exp_f32 v114, v114
    v_exp_f32 v115, v115
    ds_write_b128 v232, v[64:67] offset:2048
    v_smfmac_f32_32x32x32_bf16 v[72:87], v[192:195], v[104:111], v2
    v_exp_f32 v116, v116
    v_exp_f32 v117, v117
    v_exp_f32 v118, v118
    v_exp_f32 v119, v119
    ds_write_b128 v232, v[68:71] offset:3072
    s_setprio 0
    v_mfma_f32_32x32x16_bf16 v[136:151], v[168:171], v[32:35], 0
    v_exp_f32 v120, v120
    v_exp_f32 v121, v121
    v_exp_f32 v122, v122
    v_exp_f32 v123, v123
    v_mfma_f32_32x32x16_bf16 v[136:151], v[172:175], v[36:39], v[136:151]
    v_exp_f32 v124, v124
    v_exp_f32 v125, v125
    v_exp_f32 v126, v126
    v_exp_f32 v127, v127
    v_smfmac_f32_32x32x32_bf16 v[72:87], v[196:199], v[112:119], v2
    s_mov_b64 exec, s[72:73]
    s_add_u32 m0, s78, s79
    s_lshl2_add_u32 s41, s79, s99
    buffer_load_dwordx4 v253, s[16:19], s41 offen lds
    s_add_u32 s41, s41, 2688
    buffer_load_dwordx4 v253, s[16:19], s41 offen offset:896 lds
    s_add_u32 s79, s79, 1792
    s_cmp_lt_u32 s79, 12544
    s_cselect_b32 s79, s79, 0
    s_mov_b64 exec, -1
    v_exp_f32 v128, v128
    v_exp_f32 v129, v129
    v_exp_f32 v130, v130
    v_exp_f32 v131, v131
    v_smfmac_f32_32x32x32_bf16 v[72:87], v[208:211], v[120:127], v2
    v_exp_f32 v132, v132
    v_exp_f32 v133, v133
    v_exp_f32 v134, v134
    v_exp_f32 v135, v135
    v_mfma_f32_32x32x16_bf16 v[104:119], v[184:187], v[32:35], 0
    v_exp_f32 v136, v136
    v_exp_f32 v137, v137
    v_exp_f32 v138, v138
    v_exp_f32 v139, v139
    v_mfma_f32_32x32x16_bf16 v[104:119], v[188:191], v[36:39], v[104:119]
    v_exp_f32 v140, v140
    v_exp_f32 v141, v141
    v_exp_f32 v142, v142
    v_exp_f32 v143, v143
    v_smfmac_f32_32x32x32_bf16 v[72:87], v[212:215], v[128:135], v2
    v_add_u32 v232, s67, v6
    ds_read_b128 v[228:231], v232 offset:3072
    ds_read_b128 v[216:219], v232 offset:0
    ds_read_b128 v[220:223], v232 offset:1024
    ds_read_b128 v[224:227], v232 offset:2048
    v_exp_f32 v144, v144
    v_exp_f32 v145, v145
    v_exp_f32 v146, v146
    v_exp_f32 v147, v147
    v_smfmac_f32_32x32x32_bf16 v[88:103], v[176:179], v[136:143], v2
    v_exp_f32 v148, v148
    v_exp_f32 v149, v149
    v_exp_f32 v150, v150
    v_exp_f32 v151, v151
    s_setprio 1
    v_mfma_f32_32x32x16_bf16 v[120:135], v[200:203], v[32:35], 0
    v_exp_f32 v104, v104
    v_exp_f32 v105, v105
    v_exp_f32 v106, v106
    v_exp_f32 v107, v107
    s_waitcnt lgkmcnt(0)
    v_cmp_gt_f32 vcc, 0x3fc00000, v231
    s_nop 0
    s_andn2_b64 vcc, vcc, s[54:55]
    s_cbranch_vccnz RETRY_39
OK_41:
    v_pk_add_f32 v[72:73], v[72:73], v[216:217]
    v_pk_add_f32 v[74:75], v[74:75], v[218:219]
    v_pk_add_f32 v[76:77], v[76:77], v[220:221]
    v_pk_add_f32 v[78:79], v[78:79], v[222:223]
    v_pk_add_f32 v[80:81], v[80:81], v[224:225]
    v_pk_add_f32 v[82:83], v[82:83], v[226:227]
    v_pk_add_f32 v[84:85], v[84:85], v[228:229]
    v_pk_add_f32 v[86:87], v[86:87], v[230:231]
    ds_write_b128 v232, v[72:75] offset:0
    v_mfma_f32_32x32x16_bf16 v[120:135], v[204:207], v[36:39], v[120:135]
    v_exp_f32 v108, v108
    v_exp_f32 v109, v109
    v_exp_f32 v110, v110
    v_exp_f32 v111, v111
    ds_write_b128 v232, v[76:79] offset:1024
    v_smfmac_f32_32x32x32_bf16 v[88:103], v[180:183], v[144:151], v2
    v_exp_f32 v112, v112
    v_exp_f32 v113, v113
    v_exp_f32 v114, v114
    v_exp_f32 v115, v115
    ds_write_b128 v232, v[80:83] offset:2048
    v_smfmac_f32_32x32x32_bf16 v[88:103], v[192:195], v[104:111], v2
    v_exp_f32 v116, v116
    v_exp_f32 v117, v117
    v_exp_f32 v118, v118
    v_exp_f32 v119, v119
    ds_write_b128 v232, v[84:87] offset:3072
    v_exp_f32 v120, v120
    v_exp_f32 v121, v121
    v_exp_f32 v122, v122
    v_exp_f32 v123, v123
    v_exp_f32 v124, v124
    v_exp_f32 v125, v125
    v_exp_f32 v126, v126
    v_exp_f32 v127, v127
    v_smfmac_f32_32x32x32_bf16 v[88:103], v[196:199], v[112:119], v2
    s_lshl2_add_u32 s41, s40, 157792
    v_mov_b32 v1, s41
    s_waitcnt vmcnt(0)
    ds_write_b32 v1, v2
    s_mul_i32 s41, s62, 9363
    s_lshr_b32 s41, s41, 16
    s_lshl2_add_u32 s41, s41, s40
    s_mul_i32 s41, s41, 448
    s_add_u32 s49, s41, 589824
    v_min_u32 v246, 27, v4
    v_lshlrev_b32 v247, 4, v246
    s_add_u32 s42, s49, 0
    buffer_load_dwordx3 v[40:42], v247, s[12:15], s42 offen sc1
    s_add_u32 s42, s49, 28672
    buffer_load_dwordx3 v[44:46], v247, s[12:15], s42 offen sc1
    s_add_u32 s42, s49, 57344
    buffer_load_dwordx3 v[48:50], v247, s[12:15], s42 offen sc1
    s_add_u32 s42, s49, 86016
    buffer_load_dwordx3 v[52:54], v247, s[12:15], s42 offen sc1
    v_add_u32 v232, s68, v6
    ds_read_b128 v[228:231], v232 offset:3072
    ds_read_b128 v[216:219], v232 offset:0
    ds_read_b128 v[220:223], v232 offset:1024
    ds_read_b128 v[224:227], v232 offset:2048
    v_exp_f32 v128, v128
    v_exp_f32 v129, v129
    v_exp_f32 v130, v130
    v_exp_f32 v131, v131
    v_smfmac_f32_32x32x32_bf16 v[88:103], v[208:211], v[120:127], v2
    v_exp_f32 v132, v132
    v_exp_f32 v133, v133
    v_exp_f32 v134, v134
    v_exp_f32 v135, v135
    s_setprio 3
    s_nop 0
    v_smfmac_f32_32x32x32_bf16 v[88:103], v[212:215], v[128:135], v2
    s_waitcnt lgkmcnt(0)
    v_cmp_gt_f32 vcc, 0x40200000, v231
    s_nop 0
    s_andn2_b64 vcc, vcc, s[54:55]
    s_cbranch_vccnz RETRY_42
OK_44:
    s_nop 6
    v_pk_add_f32 v[88:89], v[88:89], v[216:217]
    v_pk_add_f32 v[90:91], v[90:91], v[218:219]
    ds_write_b128 v232, v[88:91] offset:0
    v_pk_add_f32 v[92:93], v[92:93], v[220:221]
    v_pk_add_f32 v[94:95], v[94:95], v[222:223]
    ds_write_b128 v232, v[92:95] offset:1024
    v_pk_add_f32 v[96:97], v[96:97], v[224:225]
    v_pk_add_f32 v[98:99], v[98:99], v[226:227]
    ds_write_b128 v232, v[96:99] offset:2048
    v_pk_add_f32 v[100:101], v[100:101], v[228:229]
    v_pk_add_f32 v[102:103], v[102:103], v[230:231]
    ds_write_b128 v232, v[100:103] offset:3072
    s_setprio 0
    s_mul_i32 s41, s40, 56
    s_add_u32 s41, s41, 159552
    v_lshl_add_u32 v246, v246, 1, s41
    v_mov_b32 v248, 0
    ds_write_b16 v246, v248 offset:448
    v_mul_u32_u24 v249, 224, v5
    v_add_u32 v246, v246, v249
    s_waitcnt vmcnt(0)
    v_xor_b32 v43, s36, v42
    v_xor_b32 v47, s36, v46
    v_xor_b32 v51, s36, v50
    v_or3_b32 v43, v43, v47, v51
    v_xor_b32 v47, s36, v54
    v_or_b32 v43, v43, v47
    v_cmp_ne_u32 vcc, 0, v43
    s_cbranch_vccnz RETRY_45
OK_47:
    v_cndmask_b32 v40, v41, v40, s[54:55]
    v_cndmask_b32 v44, v45, v44, s[54:55]
    v_cndmask_b32 v48, v49, v48, s[54:55]
    v_cndmask_b32 v52, v53, v52, s[54:55]
    v_add_f32 v40, v40, v44
    v_add_f32 v48, v48, v52
    v_cvt_pk_bf16_f32 v41, v40, v48
    v_lshlrev_b32 v40, 16, v41
    v_and_b32 v48, 0xffff0000, v41
    v_mul_f32 v42, 0xbfb8aa3b, v40
    v_exp_f32 v42, v42
    s_nop 0
    v_add_f32 v42, 1.0, v42
    v_rcp_f32 v42, v42
    s_nop 0
    v_mul_f32 v40, v40, v42
    v_cvt_pk_bf16_f32 v40, v40, v40
    v_lshlrev_b32 v40, 16, v40
    v_mul_f32 v40, v40, v48
    v_cvt_pk_bf16_f32 v40, v40, v40
    ds_write_b16 v246, v40
    ds_write_b32 v1, v2 offset:48
    s_cmp_eq_u32 s63, 0
    s_cbranch_scc1 SIDE_48
BACK_49:
    s_setprio 0
    s_branch L_P3
L_LATE_V:
    s_setprio 1
    s_waitcnt lgkmcnt(0)
    s_barrier
    ds_read_b128 v[32:35], v8 offset:0
    ds_read_b128 v[36:39], v9 offset:0
    ds_read_b128 v[40:43], v10 offset:0
    ds_read_b128 v[44:47], v11 offset:0
    ds_read_b128 v[48:51], v8 offset:8192
    ds_read_b128 v[52:55], v9 offset:8192
    s_waitcnt lgkmcnt(5)
    v_mfma_f32_32x32x16_bf16 v[16:31], v[32:35], v[128:131], 0
    ds_read_b128 v[56:59], v10 offset:8192
    s_mul_i32 s41, s69, 1344
    s_add_u32 m0, s51, 135168
    s_add_u32 s41, s41, s45
    buffer_load_dwordx4 v7, s[8:11], s41 offen lds
    s_waitcnt lgkmcnt(5)
    v_mfma_f32_32x32x16_bf16 v[16:31], v[36:39], v[132:135], v[16:31]
    ds_read_b128 v[60:63], v11 offset:8192
    s_waitcnt lgkmcnt(5)
    v_mfma_f32_32x32x16_bf16 v[16:31], v[40:43], v[136:139], v[16:31]
    ds_read_b128 v[32:35], v8 offset:16384
    s_mul_i32 s41, s70, 1344
    s_add_u32 m0, s51, 139264
    s_add_u32 s41, s41, s45
    buffer_load_dwordx4 v7, s[8:11], s41 offen lds
    s_waitcnt lgkmcnt(5)
    v_mfma_f32_32x32x16_bf16 v[16:31], v[44:47], v[140:143], v[16:31]
    ds_read_b128 v[36:39], v9 offset:16384
    s_lshl_b32 s74, s74, 11
    s_add_u32 s74, s74, 3145728
    s_waitcnt lgkmcnt(5)
    v_mfma_f32_32x32x16_bf16 v[16:31], v[48:51], v[144:147], v[16:31]
    ds_read_b128 v[40:43], v10 offset:16384
    s_lshl1_add_u32 s43, s39, s48
    s_lshl_b32 s43, s43, 5
    s_waitcnt lgkmcnt(5)
    v_mfma_f32_32x32x16_bf16 v[16:31], v[52:55], v[148:151], v[16:31]
    ds_read_b128 v[44:47], v11 offset:16384
    s_sub_u32 s43, s43, 448
    v_add_u32 v84, s43, v4
    s_waitcnt lgkmcnt(5)
    v_mfma_f32_32x32x16_bf16 v[16:31], v[56:59], v[152:155], v[16:31]
    ds_read_b128 v[48:51], v8 offset:24576
    v_mul_u32_u24 v85, 2341, v84
    v_lshrrev_b32 v85, 16, v85
    s_waitcnt lgkmcnt(5)
    v_mfma_f32_32x32x16_bf16 v[16:31], v[60:63], v[156:159], v[16:31]
    ds_read_b128 v[52:55], v9 offset:24576
    v_mul_u32_u24 v86, 130624, v85
    v_lshl_add_u32 v86, v84, 4, v86
    s_waitcnt lgkmcnt(5)
    v_mfma_f32_32x32x16_bf16 v[16:31], v[32:35], v[160:163], v[16:31]
    ds_read_b128 v[56:59], v10 offset:24576
    v_lshl_add_u32 v124, v5, 9, v86
    s_waitcnt lgkmcnt(5)
    v_mfma_f32_32x32x16_bf16 v[16:31], v[36:39], v[164:167], v[16:31]
    ds_read_b128 v[60:63], v11 offset:24576
    s_waitcnt lgkmcnt(5)
    v_mfma_f32_32x32x16_bf16 v[16:31], v[40:43], v[168:171], v[16:31]
    ds_read_b128 v[32:35], v8 offset:32768
    s_waitcnt lgkmcnt(5)
    v_mfma_f32_32x32x16_bf16 v[16:31], v[44:47], v[172:175], v[16:31]
    ds_read_b128 v[36:39], v9 offset:32768
    s_waitcnt lgkmcnt(5)
    v_mfma_f32_32x32x16_bf16 v[16:31], v[48:51], v[176:179], v[16:31]
    ds_read_b128 v[40:43], v10 offset:32768
    s_waitcnt lgkmcnt(5)
    v_mfma_f32_32x32x16_bf16 v[16:31], v[52:55], v[180:183], v[16:31]
    ds_read_b128 v[44:47], v11 offset:32768
    s_waitcnt lgkmcnt(5)
    v_mfma_f32_32x32x16_bf16 v[16:31], v[56:59], v[184:187], v[16:31]
    ds_read_b128 v[48:51], v8 offset:40960
    s_waitcnt lgkmcnt(5)
    v_mfma_f32_32x32x16_bf16 v[16:31], v[60:63], v[188:191], v[16:31]
    ds_read_b128 v[52:55], v9 offset:40960
    s_waitcnt lgkmcnt(5)
    v_mfma_f32_32x32x16_bf16 v[16:31], v[32:35], v[192:195], v[16:31]
    ds_read_b128 v[56:59], v10 offset:40960
    s_waitcnt lgkmcnt(5)
    v_mfma_f32_32x32x16_bf16 v[16:31], v[36:39], v[196:199], v[16:31]
    ds_read_b128 v[60:63], v11 offset:40960
    s_waitcnt lgkmcnt(5)
    v_mfma_f32_32x32x16_bf16 v[16:31], v[40:43], v[200:203], v[16:31]
    ds_read_b128 v[32:35], v8 offset:49152
    s_waitcnt lgkmcnt(5)
    v_mfma_f32_32x32x16_bf16 v[16:31], v[44:47], v[204:207], v[16:31]
    ds_read_b128 v[36:39], v9 offset:49152
    s_waitcnt lgkmcnt(5)
    v_mfma_f32_32x32x16_bf16 v[16:31], v[48:51], v[208:211], v[16:31]
    ds_read_b128 v[40:43], v10 offset:49152
    s_waitcnt lgkmcnt(5)
    v_mfma_f32_32x32x16_bf16 v[16:31], v[52:55], v[212:215], v[16:31]
    ds_read_b128 v[44:47], v11 offset:49152
    ds_read_b32 v76, v127
    s_waitcnt lgkmcnt(6)
    v_mfma_f32_32x32x16_bf16 v[16:31], v[56:59], v[216:219], v[16:31]
    s_waitcnt lgkmcnt(5)
    v_mfma_f32_32x32x16_bf16 v[16:31], v[60:63], v[220:223], v[16:31]
    s_waitcnt lgkmcnt(0)
    v_mfma_f32_32x32x16_bf16 v[16:31], v[32:35], v[224:227], v[16:31]
    s_waitcnt vmcnt(7)
    v_cmp_ne_u32 vcc, s36, v67
    s_cbranch_vccnz RETRY_56
OK_58:
    ds_write_b32 v249, v65
    ds_read_b128 v[88:91], v250 offset:0
    ds_read_b128 v[92:95], v250 offset:32
    v_mfma_f32_32x32x16_bf16 v[16:31], v[36:39], v[228:231], v[16:31]
    ds_read_b128 v[96:99], v250 offset:64
    ds_read_b128 v[100:103], v250 offset:96
    v_xor_b32 v72, 0x80000000, v64
    v_cndmask_b32 v72, 0, v72, s[54:55]
    v_mfma_f32_32x32x16_bf16 v[16:31], v[40:43], v[232:235], v[16:31]
    v_lshrrev_b32 v73, 16, v72
    v_or_b32 v74, v72, v73
    v_or_b32 v75, v72, v73
    v_or_b32 v73, v72, v73
    v_mfma_f32_32x32x16_bf16 v[16:31], v[44:47], v[236:239], v[16:31]
    v_mov_b32 v72, v74
    s_nop 1
    v_mfma_f32_32x32x16_bf16 v[16:31], v[72:75], v[76:79], v[16:31]
    s_waitcnt vmcnt(3) lgkmcnt(0)
    s_barrier
    s_nop 9
    v_mul_f32 v16, v16, v88
    v_mul_f32 v17, v17, v89
    v_cvt_pk_bf16_f32 v104, v16, v17
    v_mul_f32 v18, v18, v90
    v_mul_f32 v19, v19, v91
    v_cvt_pk_bf16_f32 v105, v18, v19
    v_mul_f32 v20, v20, v92
    v_mul_f32 v21, v21, v93
    v_cvt_pk_bf16_f32 v106, v20, v21
    v_mul_f32 v22, v22, v94
    v_mul_f32 v23, v23, v95
    v_cvt_pk_bf16_f32 v107, v22, v23
    buffer_store_dwordx4 v[104:107], v124, s[12:15], s74 offen offset:0 sc1
    v_mul_f32 v24, v24, v96
    v_mul_f32 v25, v25, v97
    v_cvt_pk_bf16_f32 v108, v24, v25
    v_mul_f32 v26, v26, v98
    v_mul_f32 v27, v27, v99
    v_cvt_pk_bf16_f32 v109, v26, v27
    v_mul_f32 v28, v28, v100
    v_mul_f32 v29, v29, v101
    v_cvt_pk_bf16_f32 v110, v28, v29
    v_mul_f32 v30, v30, v102
    v_mul_f32 v31, v31, v103
    v_cvt_pk_bf16_f32 v111, v30, v31
    buffer_store_dwordx4 v[108:111], v124, s[12:15], s74 offen offset:1024 sc1
    s_waitcnt vmcnt(2)
L_LJOIN:
    ds_read_b64_tr_b16 v[32:33], v125 offset:0
    ds_read_b64_tr_b16 v[34:35], v125 offset:256
    ds_read_b64_tr_b16 v[36:37], v125 offset:4096
    ds_read_b64_tr_b16 v[38:39], v125 offset:4352
    ds_read_b64_tr_b16 v[40:41], v125 offset:8192
    ds_read_b64_tr_b16 v[42:43], v125 offset:8448
    ds_read_b64_tr_b16 v[44:45], v125 offset:12288
    ds_read_b64_tr_b16 v[46:47], v125 offset:12544
    ds_read_b64_tr_b16 v[48:49], v125 offset:16384
    ds_read_b64_tr_b16 v[50:51], v125 offset:16640
    ds_read_b64_tr_b16 v[52:53], v125 offset:20480
    ds_read_b64_tr_b16 v[54:55], v125 offset:20736
    ds_read_b64_tr_b16 v[56:57], v125 offset:24576
    ds_read_b64_tr_b16 v[58:59], v125 offset:24832
    v_mov_b32 v160, v248
    v_mov_b32 v161, v248
    v_mov_b64 v[162:163], v[160:161]
    v_mov_b64 v[164:165], v[160:161]
    v_mov_b64 v[166:167], v[160:161]
    v_mov_b64 v[176:177], v[160:161]
    v_mov_b64 v[178:179], v[160:161]
    v_mov_b64 v[180:181], v[160:161]
    v_mov_b64 v[182:183], v[160:161]
    s_waitcnt lgkmcnt(12)
    v_mfma_f32_16x16x32_bf16 v[112:115], v[120:123], v[32:35], 0
    s_waitcnt lgkmcnt(10)
    v_mfma_f32_16x16x32_bf16 v[112:115], v[120:123], v[36:39], v[112:115]
    s_waitcnt lgkmcnt(8)
    v_mfma_f32_16x16x32_bf16 v[112:115], v[120:123], v[40:43], v[112:115]
    s_waitcnt lgkmcnt(6)
    v_mfma_f32_16x16x32_bf16 v[112:115], v[120:123], v[44:47], v[112:115]
    s_waitcnt lgkmcnt(4)
    v_mfma_f32_16x16x32_bf16 v[112:115], v[120:123], v[48:51], v[112:115]
    s_waitcnt lgkmcnt(2)
    v_mfma_f32_16x16x32_bf16 v[112:115], v[120:123], v[52:55], v[112:115]
    s_waitcnt lgkmcnt(0)
    v_mfma_f32_16x16x32_bf16 v[112:115], v[120:123], v[56:59], v[112:115]
    v_mov_b64 v[192:193], v[160:161]
    v_mov_b64 v[194:195], v[160:161]
    v_mov_b64 v[196:197], v[160:161]
    v_mov_b64 v[198:199], v[160:161]
    v_mov_b64 v[208:209], v[160:161]
    v_mov_b64 v[210:211], v[160:161]
    v_mov_b64 v[212:213], v[160:161]
    v_mov_b64 v[214:215], v[160:161]
    v_cvt_pk_bf16_f32 v84, v112, v112
    v_and_b32 v85, 0xffff0000, v84
    v_sub_f32 v85, v112, v85
    v_cvt_pk_bf16_f32 v84, v85, v112
    ds_write_b32 v80, v84
    s_mov_b32 s70, 15
    s_and_b32 s41, s38, 3
    s_lshl_b32 s69, -1, s41
    s_mov_b32 s37, s36
    s_setprio 0
    s_waitcnt lgkmcnt(0)
    s_load_dwordx4 s[80:83], s[76:77], 0 glc
    s_load_dwordx4 s[84:87], s[76:77], 32768 glc
    s_load_dwordx4 s[88:91], s[76:77], 65536 glc
    s_load_dwordx4 s[92:95], s[76:77], 98304 glc
    s_barrier
    s_lshl_b32 s41, s40, 8
    s_add_u32 s41, s41, s2
    s_cmp_eq_u32 s41, 1279
    s_cbranch_scc1 SIDE_59
BACK_60:
    v_mov_b32 v120, 0x3f803f80
    v_mov_b32 v121, 0x3f803f80
    v_mov_b32 v122, 0x3f803f80
    v_mov_b32 v123, 0x3f803f80
    s_and_b32 s42, s40, 4
    s_add_u32 s41, s40, 1
    s_and_b32 s41, s41, 3
    s_or_b32 s41, s41, s42
    s_lshl_b32 s41, s41, 12
    s_add_u32 s65, s41, 100352
    s_add_u32 s41, s40, 2
    s_and_b32 s41, s41, 3
    s_or_b32 s41, s41, s42
    s_lshl_b32 s41, s41, 12
    s_add_u32 s66, s41, 100352
    s_add_u32 s41, s40, 3
    s_and_b32 s41, s41, 3
    s_or_b32 s41, s41, s42
    s_lshl_b32 s41, s41, 12
    s_add_u32 s67, s41, 100352
    s_add_u32 s41, s40, 4
    s_and_b32 s41, s41, 3
    s_or_b32 s41, s41, s42
    s_lshl_b32 s41, s41, 12
    s_add_u32 s68, s41, 100352
    v_add_u32 v1, s68, v6
    s_cmp_lt_u32 s2, 224
    s_cselect_b32 s63, s40, 8
    v_mov_b64 v[40:41], 0
    v_mov_b64 v[42:43], 0
    v_mov_b64 v[44:45], 0
    v_mov_b64 v[46:47], 0
    v_mov_b64 v[48:49], 0
    v_mov_b64 v[50:51], 0
    v_mov_b64 v[52:53], 0
    v_mov_b32 v54, 0
    v_cvt_f32_u32 v55, v5
    v_mov_b64 v[56:57], 0
    v_mov_b64 v[58:59], 0
    v_mov_b64 v[60:61], 0
    v_mov_b64 v[62:63], 0
    v_mov_b64 v[64:65], 0
    v_mov_b64 v[66:67], 0
    v_mov_b64 v[68:69], 0
    v_mov_b32 v70, 0
    v_cvt_f32_u32 v71, v5
    v_mov_b64 v[72:73], 0
    v_mov_b64 v[74:75], 0
    v_mov_b64 v[76:77], 0
    v_mov_b64 v[78:79], 0
    v_mov_b64 v[80:81], 0
    v_mov_b64 v[82:83], 0
    v_mov_b64 v[84:85], 0
    v_mov_b32 v86, 0
    v_cvt_f32_u32 v87, v5
    v_mov_b64 v[88:89], 0
    v_mov_b64 v[90:91], 0
    v_mov_b64 v[92:93], 0
    v_mov_b64 v[94:95], 0
    v_mov_b64 v[96:97], 0
    v_mov_b64 v[98:99], 0
    v_mov_b64 v[100:101], 0
    v_mov_b32 v102, 0
    v_cvt_f32_u32 v103, v5
    s_mov_b32 s32, 0
LOOK_62:
    s_waitcnt lgkmcnt(0)
    s_xor_b64 vcc, s[92:93], s[36:37]
    s_xor_b64 s[42:43], s[94:95], s[36:37]
    s_or_b64 vcc, vcc, s[42:43]
    s_addc_u32 s33, s33, s33
    s_xor_b64 vcc, s[88:89], s[36:37]
    s_xor_b64 s[42:43], s[90:91], s[36:37]
    s_or_b64 vcc, vcc, s[42:43]
    s_addc_u32 s33, s33, s33
    s_xor_b64 vcc, s[84:85], s[36:37]
    s_xor_b64 s[42:43], s[86:87], s[36:37]
    s_or_b64 vcc, vcc, s[42:43]
    s_addc_u32 s33, s33, s33
    s_xor_b64 vcc, s[80:81], s[36:37]
    s_xor_b64 s[42:43], s[82:83], s[36:37]
    s_or_b64 vcc, vcc, s[42:43]
    s_addc_u32 s33, s33, s33
    s_andn2_b32 s41, s70, s33
    s_bcnt1_i32_b32 s41, s41
    s_cmp_lt_u32 s41, 2
    s_cbranch_scc1 PEND_61
    s_mov_b32 s32, 0
    s_andn2_b32 s41, s70, s33
    s_cbranch_scc0 PK_64
PKD_65:
    s_ff1_i32_b32 s41, s41
    s_bitset0_b32 s70, s41
    s_lshl_b32 s42, s41, 15
    s_mul_i32 s41, s41, 458752
    s_add_u32 s42, s42, s98
    s_add_u32 s41, s41, s59
    buffer_load_dwordx4 v[152:155], v6, s[12:15], s41 offen offset:0 sc1
    buffer_load_dwordx4 v[156:159], v6, s[12:15], s41 offen offset:1024 sc1
    s_mov_b64 exec, s[52:53]
    buffer_load_dwordx4 v[160:163], v6, s[12:15], s42 offen offset:0 sc1
    buffer_load_dwordx4 v[164:167], v6, s[12:15], s42 offen offset:1024 sc1
    s_mov_b64 exec, -1
    s_andn2_b32 s41, s70, s33
    s_cbranch_scc0 PK_66
PKD_67:
    s_ff1_i32_b32 s41, s41
    s_bitset0_b32 s70, s41
    s_lshl_b32 s42, s41, 15
    s_mul_i32 s41, s41, 458752
    s_add_u32 s42, s42, s98
    s_add_u32 s41, s41, s59
    buffer_load_dwordx4 v[168:171], v6, s[12:15], s41 offen offset:0 sc1
    buffer_load_dwordx4 v[172:175], v6, s[12:15], s41 offen offset:1024 sc1
    s_mov_b64 exec, s[52:53]
    buffer_load_dwordx4 v[176:179], v6, s[12:15], s42 offen offset:0 sc1
    buffer_load_dwordx4 v[180:183], v6, s[12:15], s42 offen offset:1024 sc1
    s_mov_b64 exec, -1
    s_waitcnt vmcnt(8)
PENDD_63:
    v_mov_b32 v216, s36
    s_mov_b64 exec, 7
    buffer_store_dword v216, v251, s[12:15], s75 offen sc1
    s_mov_b64 exec, -1
    s_setprio 3
    s_barrier
    ds_read_b128 v[8:11], v244
    ds_read_b128 v[12:15], v244 offset:1024
    ds_read_b128 v[16:19], v245
    ds_read_b128 v[20:23], v245 offset:1024
    ds_read_b128 v[24:27], v246
    ds_read_b128 v[28:31], v246 offset:1024
    ds_read_b128 v[32:35], v247
    ds_read_b128 v[36:39], v247 offset:1024
    ds_write_b128 v1, v[240:243] offset:3072
    s_cmp_lg_u32 s32, 0
    s_cbranch_scc1 SIDE_69
BACK_70:
    s_waitcnt vmcnt(7) lgkmcnt(5)
    v_mfma_f32_32x32x16_bf16 v[104:119], v[152:155], v[8:11], 0
    v_mfma_f32_32x32x16_bf16 v[104:119], v[156:159], v[12:15], v[104:119]
    s_setprio 3
    v_mfma_f32_32x32x16_bf16 v[120:135], v[152:155], v[16:19], 0
    s_nop 9
    v_exp_f32 v104, v104
    v_exp_f32 v105, v105
    v_exp_f32 v106, v106
    v_exp_f32 v107, v107
    v_mfma_f32_32x32x16_bf16 v[120:135], v[156:159], v[20:23], v[120:135]
    v_exp_f32 v108, v108
    v_exp_f32 v109, v109
    v_exp_f32 v110, v110
    v_exp_f32 v111, v111
    s_waitcnt lgkmcnt(0)
    s_barrier
    v_exp_f32 v112, v112
    v_exp_f32 v113, v113
    v_exp_f32 v114, v114
    v_exp_f32 v115, v115
    s_waitcnt vmcnt(5)
    v_smfmac_f32_32x32x32_bf16 v[40:55], v[160:163], v[104:111], v2
    v_exp_f32 v116, v116
    v_exp_f32 v117, v117
    v_exp_f32 v118, v118
    v_exp_f32 v119, v119
    v_mfma_f32_32x32x16_bf16 v[136:151], v[152:155], v[24:27], 0
    v_exp_f32 v120, v120
    v_exp_f32 v121, v121
    v_exp_f32 v122, v122
    v_exp_f32 v123, v123
    v_mfma_f32_32x32x16_bf16 v[136:151], v[156:159], v[28:31], v[136:151]
    v_exp_f32 v124, v124
    v_exp_f32 v125, v125
    v_exp_f32 v126, v126
    v_exp_f32 v127, v127
    v_smfmac_f32_32x32x32_bf16 v[40:55], v[164:167], v[112:119], v2
    s_and_b32 s41, s70, s33
    s_cbranch_scc1 SIDE_75
BACK_76:
    v_exp_f32 v128, v128
    v_exp_f32 v129, v129
    v_exp_f32 v130, v130
    v_exp_f32 v131, v131
    v_smfmac_f32_32x32x32_bf16 v[56:71], v[160:163], v[120:127], v2
    v_exp_f32 v132, v132
    v_exp_f32 v133, v133
    v_exp_f32 v134, v134
    v_exp_f32 v135, v135
    v_mfma_f32_32x32x16_bf16 v[104:119], v[152:155], v[32:35], 0
    v_exp_f32 v136, v136
    v_exp_f32 v137, v137
    v_exp_f32 v138, v138
    v_exp_f32 v139, v139
    v_mfma_f32_32x32x16_bf16 v[104:119], v[156:159], v[36:39], v[104:119]
    v_exp_f32 v140, v140
    v_exp_f32 v141, v141
    v_exp_f32 v142, v142
    v_exp_f32 v143, v143
    v_smfmac_f32_32x32x32_bf16 v[56:71], v[164:167], v[128:135], v2
    v_exp_f32 v144, v144
    v_exp_f32 v145, v145
    v_exp_f32 v146, v146
    v_exp_f32 v147, v147
    v_smfmac_f32_32x32x32_bf16 v[72:87], v[160:163], v[136:143], v2
    v_exp_f32 v148, v148
    v_exp_f32 v149, v149
    v_exp_f32 v150, v150
    v_exp_f32 v151, v151
    s_waitcnt vmcnt(3)
    v_mfma_f32_32x32x16_bf16 v[120:135], v[168:171], v[8:11], 0
    v_exp_f32 v104, v104
    v_exp_f32 v105, v105
    v_exp_f32 v106, v106
    v_exp_f32 v107, v107
    v_mfma_f32_32x32x16_bf16 v[120:135], v[172:175], v[12:15], v[120:135]
    v_exp_f32 v108, v108
    v_exp_f32 v109, v109
    v_exp_f32 v110, v110
    v_exp_f32 v111, v111
    v_smfmac_f32_32x32x32_bf16 v[72:87], v[164:167], v[144:151], v2
    v_exp_f32 v112, v112
    v_exp_f32 v113, v113
    v_exp_f32 v114, v114
    v_exp_f32 v115, v115
    v_smfmac_f32_32x32x32_bf16 v[88:103], v[160:163], v[104:111], v2
    v_exp_f32 v116, v116
    v_exp_f32 v117, v117
    v_exp_f32 v118, v118
    v_exp_f32 v119, v119
    v_mfma_f32_32x32x16_bf16 v[136:151], v[168:171], v[16:19], 0
    v_exp_f32 v120, v120
    v_exp_f32 v121, v121
    v_exp_f32 v122, v122
    v_exp_f32 v123, v123
    v_mfma_f32_32x32x16_bf16 v[136:151], v[172:175], v[20:23], v[136:151]
    v_exp_f32 v124, v124
    v_exp_f32 v125, v125
    v_exp_f32 v126, v126
    v_exp_f32 v127, v127
    v_smfmac_f32_32x32x32_bf16 v[88:103], v[164:167], v[112:119], v2
    s_andn2_b32 s41, s70, s33
    s_cbranch_scc0 PK_77
PKD_78:
    s_ff1_i32_b32 s41, s41
    s_bitset0_b32 s70, s41
    s_lshl_b32 s42, s41, 15
    s_mul_i32 s41, s41, 458752
    s_add_u32 s42, s42, s98
    s_add_u32 s41, s41, s59
    buffer_load_dwordx4 v[184:187], v6, s[12:15], s41 offen offset:0 sc1
    buffer_load_dwordx4 v[188:191], v6, s[12:15], s41 offen offset:1024 sc1
    s_mov_b64 exec, s[52:53]
    buffer_load_dwordx4 v[192:195], v6, s[12:15], s42 offen offset:0 sc1
    buffer_load_dwordx4 v[196:199], v6, s[12:15], s42 offen offset:1024 sc1
    s_mov_b64 exec, -1
    v_exp_f32 v128, v128
    v_exp_f32 v129, v129
    v_exp_f32 v130, v130
    v_exp_f32 v131, v131
    s_waitcnt vmcnt(5)
    v_smfmac_f32_32x32x32_bf16 v[40:55], v[176:179], v[120:127], v2
    v_exp_f32 v132, v132
    v_exp_f32 v133, v133
    v_exp_f32 v134, v134
    v_exp_f32 v135, v135
    v_mfma_f32_32x32x16_bf16 v[104:119], v[168:171], v[24:27], 0
    v_exp_f32 v136, v136
    v_exp_f32 v137, v137
    v_exp_f32 v138, v138
    v_exp_f32 v139, v139
    v_mfma_f32_32x32x16_bf16 v[104:119], v[172:175], v[28:31], v[104:119]
    v_exp_f32 v140, v140
    v_exp_f32 v141, v141
    v_exp_f32 v142, v142
    v_exp_f32 v143, v143
    v_smfmac_f32_32x32x32_bf16 v[40:55], v[180:183], v[128:135], v2
    v_exp_f32 v144, v144
    v_exp_f32 v145, v145
    v_exp_f32 v146, v146
    v_exp_f32 v147, v147
    v_smfmac_f32_32x32x32_bf16 v[56:71], v[176:179], v[136:143], v2
    v_exp_f32 v148, v148
    v_exp_f32 v149, v149
    v_exp_f32 v150, v150
    v_exp_f32 v151, v151
    v_mfma_f32_32x32x16_bf16 v[120:135], v[168:171], v[32:35], 0
    v_exp_f32 v104, v104
    v_exp_f32 v105, v105
    v_exp_f32 v106, v106
    v_exp_f32 v107, v107
    v_mfma_f32_32x32x16_bf16 v[120:135], v[172:175], v[36:39], v[120:135]
    v_exp_f32 v108, v108
    v_exp_f32 v109, v109
    v_exp_f32 v110, v110
    v_exp_f32 v111, v111
    v_smfmac_f32_32x32x32_bf16 v[56:71], v[180:183], v[144:151], v2
    s_andn2_b32 s41, s70, s33
    s_cbranch_scc0 PK_79
PKD_80:
    s_ff1_i32_b32 s41, s41
    s_bitset0_b32 s70, s41
    s_lshl_b32 s42, s41, 15
    s_mul_i32 s41, s41, 458752
    s_add_u32 s42, s42, s98
    s_add_u32 s41, s41, s59
    buffer_load_dwordx4 v[200:203], v6, s[12:15], s41 offen offset:0 sc1
    buffer_load_dwordx4 v[204:207], v6, s[12:15], s41 offen offset:1024 sc1
    s_mov_b64 exec, s[52:53]
    buffer_load_dwordx4 v[208:211], v6, s[12:15], s42 offen offset:0 sc1
    buffer_load_dwordx4 v[212:215], v6, s[12:15], s42 offen offset:1024 sc1
    s_mov_b64 exec, -1
    v_exp_f32 v112, v112
    v_exp_f32 v113, v113
    v_exp_f32 v114, v114
    v_exp_f32 v115, v115
    v_smfmac_f32_32x32x32_bf16 v[72:87], v[176:179], v[104:111], v2
    v_exp_f32 v116, v116
    v_exp_f32 v117, v117
    v_exp_f32 v118, v118
    v_exp_f32 v119, v119
    s_waitcnt vmcnt(6)
    v_mfma_f32_32x32x16_bf16 v[136:151], v[184:187], v[8:11], 0
    v_exp_f32 v120, v120
    v_exp_f32 v121, v121
    v_exp_f32 v122, v122
    v_exp_f32 v123, v123
    v_mfma_f32_32x32x16_bf16 v[136:151], v[188:191], v[12:15], v[136:151]
    v_exp_f32 v124, v124
    v_exp_f32 v125, v125
    v_exp_f32 v126, v126
    v_exp_f32 v127, v127
    v_smfmac_f32_32x32x32_bf16 v[72:87], v[180:183], v[112:119], v2
    v_exp_f32 v128, v128
    v_exp_f32 v129, v129
    v_exp_f32 v130, v130
    v_exp_f32 v131, v131
    v_smfmac_f32_32x32x32_bf16 v[88:103], v[176:179], v[120:127], v2
    v_exp_f32 v132, v132
    v_exp_f32 v133, v133
    v_exp_f32 v134, v134
    v_exp_f32 v135, v135
    v_mfma_f32_32x32x16_bf16 v[104:119], v[184:187], v[16:19], 0
    v_exp_f32 v136, v136
    v_exp_f32 v137, v137
    v_exp_f32 v138, v138
    v_exp_f32 v139, v139
    v_mfma_f32_32x32x16_bf16 v[104:119], v[188:191], v[20:23], v[104:119]
    v_exp_f32 v140, v140
    v_exp_f32 v141, v141
    v_exp_f32 v142, v142
    v_exp_f32 v143, v143
    v_smfmac_f32_32x32x32_bf16 v[88:103], v[180:183], v[128:135], v2
    s_load_dwordx4 s[80:83], s[76:77], 4096 glc
    s_load_dwordx4 s[84:87], s[76:77], 36864 glc
    s_load_dwordx4 s[88:91], s[76:77], 69632 glc
    s_load_dwordx4 s[92:95], s[76:77], 102400 glc
    v_exp_f32 v144, v144
    v_exp_f32 v145, v145
    v_exp_f32 v146, v146
    v_exp_f32 v147, v147
    s_waitcnt vmcnt(4)
    v_smfmac_f32_32x32x32_bf16 v[40:55], v[192:195], v[136:143], v2
    v_exp_f32 v148, v148
    v_exp_f32 v149, v149
    v_exp_f32 v150, v150
    v_exp_f32 v151, v151
    v_mfma_f32_32x32x16_bf16 v[120:135], v[184:187], v[24:27], 0
    v_exp_f32 v104, v104
    v_exp_f32 v105, v105
    v_exp_f32 v106, v106
    v_exp_f32 v107, v107
    v_mfma_f32_32x32x16_bf16 v[120:135], v[188:191], v[28:31], v[120:135]
    v_exp_f32 v108, v108
    v_exp_f32 v109, v109
    v_exp_f32 v110, v110
    v_exp_f32 v111, v111
    v_smfmac_f32_32x32x32_bf16 v[40:55], v[196:199], v[144:151], v2
    v_exp_f32 v112, v112
    v_exp_f32 v113, v113
    v_exp_f32 v114, v114
    v_exp_f32 v115, v115
    v_smfmac_f32_32x32x32_bf16 v[56:71], v[192:195], v[104:111], v2
    v_exp_f32 v116, v116
    v_exp_f32 v117, v117
    v_exp_f32 v118, v118
    v_exp_f32 v119, v119
    v_mfma_f32_32x32x16_bf16 v[136:151], v[184:187], v[32:35], 0
    v_exp_f32 v120, v120
    v_exp_f32 v121, v121
    v_exp_f32 v122, v122
    v_exp_f32 v123, v123
    v_mfma_f32_32x32x16_bf16 v[136:151], v[188:191], v[36:39], v[136:151]
    v_exp_f32 v124, v124
    v_exp_f32 v125, v125
    v_exp_f32 v126, v126
    v_exp_f32 v127, v127
    v_smfmac_f32_32x32x32_bf16 v[56:71], v[196:199], v[112:119], v2
    v_exp_f32 v128, v128
    v_exp_f32 v129, v129
    v_exp_f32 v130, v130
    v_exp_f32 v131, v131
    v_smfmac_f32_32x32x32_bf16 v[72:87], v[192:195], v[120:127], v2
    v_exp_f32 v132, v132
    v_exp_f32 v133, v133
    v_exp_f32 v134, v134
    v_exp_f32 v135, v135
    s_waitcnt vmcnt(2)
    v_mfma_f32_32x32x16_bf16 v[104:119], v[200:203], v[8:11], 0
    v_exp_f32 v136, v136
    v_exp_f32 v137, v137
    v_exp_f32 v138, v138
    v_exp_f32 v139, v139
    v_mfma_f32_32x32x16_bf16 v[104:119], v[204:207], v[12:15], v[104:119]
    v_exp_f32 v140, v140
    v_exp_f32 v141, v141
    v_exp_f32 v142, v142
    v_exp_f32 v143, v143
    v_smfmac_f32_32x32x32_bf16 v[72:87], v[196:199], v[128:135], v2
    s_waitcnt lgkmcnt(0)
    s_xor_b64 vcc, s[92:93], s[36:37]
    s_xor_b64 s[42:43], s[94:95], s[36:37]
    s_or_b64 vcc, vcc, s[42:43]
    s_addc_u32 s33, s33, s33
    s_xor_b64 vcc, s[88:89], s[36:37]
    s_xor_b64 s[42:43], s[90:91], s[36:37]
    s_or_b64 vcc, vcc, s[42:43]
    s_addc_u32 s33, s33, s33
    s_xor_b64 vcc, s[84:85], s[36:37]
    s_xor_b64 s[42:43], s[86:87], s[36:37]
    s_or_b64 vcc, vcc, s[42:43]
    s_addc_u32 s33, s33, s33
    s_xor_b64 vcc, s[80:81], s[36:37]
    s_xor_b64 s[42:43], s[82:83], s[36:37]
    s_or_b64 vcc, vcc, s[42:43]
    s_addc_u32 s33, s33, s33
    s_mov_b32 s70, 15
    s_andn2_b32 s41, s70, s33
    s_cbranch_scc0 PK_81
PKD_82:
    s_ff1_i32_b32 s41, s41
    s_bitset0_b32 s70, s41
    s_lshl_b32 s42, s41, 15
    s_mul_i32 s41, s41, 458752
    s_add_u32 s98, s98, 4096
    s_add_u32 s59, s59, 57344
    s_add_u32 s42, s42, s98
    s_add_u32 s41, s41, s59
    buffer_load_dwordx4 v[152:155], v6, s[12:15], s41 offen offset:0 sc1
    buffer_load_dwordx4 v[156:159], v6, s[12:15], s41 offen offset:1024 sc1
    s_mov_b64 exec, s[52:53]
    buffer_load_dwordx4 v[160:163], v6, s[12:15], s42 offen offset:0 sc1
    buffer_load_dwordx4 v[164:167], v6, s[12:15], s42 offen offset:1024 sc1
    s_mov_b64 exec, -1
    v_exp_f32 v144, v144
    v_exp_f32 v145, v145
    v_exp_f32 v146, v146
    v_exp_f32 v147, v147
    v_smfmac_f32_32x32x32_bf16 v[88:103], v[192:195], v[136:143], v2
    v_exp_f32 v148, v148
    v_exp_f32 v149, v149
    v_exp_f32 v150, v150
    v_exp_f32 v151, v151
    v_mfma_f32_32x32x16_bf16 v[120:135], v[200:203], v[16:19], 0
    v_exp_f32 v104, v104
    v_exp_f32 v105, v105
    v_exp_f32 v106, v106
    v_exp_f32 v107, v107
    v_mfma_f32_32x32x16_bf16 v[120:135], v[204:207], v[20:23], v[120:135]
    v_exp_f32 v108, v108
    v_exp_f32 v109, v109
    v_exp_f32 v110, v110
    v_exp_f32 v111, v111
    v_smfmac_f32_32x32x32_bf16 v[88:103], v[196:199], v[144:151], v2
    s_andn2_b32 s41, s70, s33
    s_cbranch_scc0 PK_83
PKD_84:
    s_ff1_i32_b32 s41, s41
    s_bitset0_b32 s70, s41
    s_lshl_b32 s42, s41, 15
    s_mul_i32 s41, s41, 458752
    s_add_u32 s42, s42, s98
    s_add_u32 s41, s41, s59
    buffer_load_dwordx4 v[168:171], v6, s[12:15], s41 offen offset:0 sc1
    buffer_load_dwordx4 v[172:175], v6, s[12:15], s41 offen offset:1024 sc1
    s_mov_b64 exec, s[52:53]
    buffer_load_dwordx4 v[176:179], v6, s[12:15], s42 offen offset:0 sc1
    buffer_load_dwordx4 v[180:183], v6, s[12:15], s42 offen offset:1024 sc1
    s_mov_b64 exec, -1
    v_exp_f32 v112, v112
    v_exp_f32 v113, v113
    v_exp_f32 v114, v114
    v_exp_f32 v115, v115
    s_waitcnt vmcnt(8)
    v_smfmac_f32_32x32x32_bf16 v[40:55], v[208:211], v[104:111], v2
    v_exp_f32 v116, v116
    v_exp_f32 v117, v117
    v_exp_f32 v118, v118
    v_exp_f32 v119, v119
    v_mfma_f32_32x32x16_bf16 v[136:151], v[200:203], v[24:27], 0
    v_exp_f32 v120, v120
    v_exp_f32 v121, v121
    v_exp_f32 v122, v122
    v_exp_f32 v123, v123
    v_mfma_f32_32x32x16_bf16 v[136:151], v[204:207], v[28:31], v[136:151]
    v_exp_f32 v124, v124
    v_exp_f32 v125, v125
    v_exp_f32 v126, v126
    v_exp_f32 v127, v127
    v_smfmac_f32_32x32x32_bf16 v[40:55], v[212:215], v[112:119], v2
    v_mov_b32 v217, 268
    buffer_load_dword v216, v217, s[12:15], 0 offen sc1
    v_exp_f32 v128, v128
    v_exp_f32 v129, v129
    v_exp_f32 v130, v130
    v_exp_f32 v131, v131
    v_smfmac_f32_32x32x32_bf16 v[56:71], v[208:211], v[120:127], v2
    v_exp_f32 v132, v132
    v_exp_f32 v133, v133
    v_exp_f32 v134, v134
    v_exp_f32 v135, v135
    v_mfma_f32_32x32x16_bf16 v[104:119], v[200:203], v[32:35], 0
    v_exp_f32 v136, v136
    v_exp_f32 v137, v137
    v_exp_f32 v138, v138
    v_exp_f32 v139, v139
    v_mfma_f32_32x32x16_bf16 v[104:119], v[204:207], v[36:39], v[104:119]
    v_exp_f32 v140, v140
    v_exp_f32 v141, v141
    v_exp_f32 v142, v142
    v_exp_f32 v143, v143
    v_smfmac_f32_32x32x32_bf16 v[56:71], v[212:215], v[128:135], v2
    s_andn2_b32 s41, s70, s33
    s_cbranch_scc0 PK_85
PKD_86:
    s_ff1_i32_b32 s41, s41
    s_bitset0_b32 s70, s41
    s_lshl_b32 s42, s41, 15
    s_mul_i32 s41, s41, 458752
    s_add_u32 s42, s42, s98
    s_add_u32 s41, s41, s59
    buffer_load_dwordx4 v[184:187], v6, s[12:15], s41 offen offset:0 sc1
    buffer_load_dwordx4 v[188:191], v6, s[12:15], s41 offen offset:1024 sc1
    s_mov_b64 exec, s[52:53]
    buffer_load_dwordx4 v[192:195], v6, s[12:15], s42 offen offset:0 sc1
    buffer_load_dwordx4 v[196:199], v6, s[12:15], s42 offen offset:1024 sc1
    s_mov_b64 exec, -1
    v_exp_f32 v144, v144
    v_exp_f32 v145, v145
    v_exp_f32 v146, v146
    v_exp_f32 v147, v147
    v_smfmac_f32_32x32x32_bf16 v[72:87], v[208:211], v[136:143], v2
    v_exp_f32 v148, v148
    v_exp_f32 v149, v149
    v_exp_f32 v150, v150
    v_exp_f32 v151, v151
    s_waitcnt vmcnt(11)
    v_mfma_f32_32x32x16_bf16 v[120:135], v[152:155], v[8:11], 0
    v_exp_f32 v104, v104
    v_exp_f32 v105, v105
    v_exp_f32 v106, v106
    v_exp_f32 v107, v107
    v_mfma_f32_32x32x16_bf16 v[120:135], v[156:159], v[12:15], v[120:135]
    v_exp_f32 v108, v108
    v_exp_f32 v109, v109
    v_exp_f32 v110, v110
    v_exp_f32 v111, v111
    v_smfmac_f32_32x32x32_bf16 v[72:87], v[212:215], v[144:151], v2
    v_cmp_lt_u32 vcc, 27, v0
    s_mul_i32 s41, s62, 2341
    s_bfe_u32 s41, s41, 0x10010
    v_add_u32 v218, 448, v6
    s_mul_i32 s41, s41, 448
    v_cndmask_b32 v218, v6, v218, vcc
    s_add_u32 s41, s41, 4096
    s_and_b32 s42, s40, 3
    s_mul_i32 s42, s42, 896
    s_add_u32 s64, s42, 160256
    s_mov_b32 m0, s64
    s_waitcnt vmcnt(4)
    v_cmp_ne_u32 vcc, s36, v216
    s_cbranch_vccnz RETRY_87
OK_89:
    s_mov_b64 exec, s[72:73]
    buffer_load_dwordx4 v218, s[12:15], s41 offen sc1 lds
    s_mov_b64 exec, -1
    v_exp_f32 v112, v112
    v_exp_f32 v113, v113
    v_exp_f32 v114, v114
    v_exp_f32 v115, v115
    v_smfmac_f32_32x32x32_bf16 v[88:103], v[208:211], v[104:111], v2
    v_exp_f32 v116, v116
    v_exp_f32 v117, v117
    v_exp_f32 v118, v118
    v_exp_f32 v119, v119
    s_setprio 2
    v_mfma_f32_32x32x16_bf16 v[136:151], v[152:155], v[16:19], 0
    v_exp_f32 v120, v120
    v_exp_f32 v121, v121
    v_exp_f32 v122, v122
    v_exp_f32 v123, v123
    v_mfma_f32_32x32x16_bf16 v[136:151], v[156:159], v[20:23], v[136:151]
    v_exp_f32 v124, v124
    v_exp_f32 v125, v125
    v_exp_f32 v126, v126
    v_exp_f32 v127, v127
    v_smfmac_f32_32x32x32_bf16 v[88:103], v[212:215], v[112:119], v2
    s_andn2_b32 s41, s70, s33
    s_cbranch_scc0 PK_90
PKD_91:
    s_ff1_i32_b32 s41, s41
    s_bitset0_b32 s70, s41
    s_lshl_b32 s42, s41, 15
    s_mul_i32 s41, s41, 458752
    s_add_u32 s42, s42, s98
    s_add_u32 s41, s41, s59
    buffer_load_dwordx4 v[200:203], v6, s[12:15], s41 offen offset:0 sc1
    buffer_load_dwordx4 v[204:207], v6, s[12:15], s41 offen offset:1024 sc1
    s_mov_b64 exec, s[52:53]
    buffer_load_dwordx4 v[208:211], v6, s[12:15], s42 offen offset:0 sc1
    buffer_load_dwordx4 v[212:215], v6, s[12:15], s42 offen offset:1024 sc1
    s_mov_b64 exec, -1
    v_mov_b32 v226, 157760
    ds_read_b128 v[222:225], v226
    v_and_b32 v220, 1, v0
    v_mul_u32_u24 v220, 448, v220
    v_and_b32 v221, 48, v0
    v_add3_u32 v220, v220, v221, s64
    v_and_b32 v216, 12, v0
    v_lshl_add_u32 v221, v221, 1, v216
    s_and_b32 s41, s40, 1
    s_lshl_b32 s41, s41, 5
    s_add_u32 s41, s41, 135168
    v_and_b32 v216, 24, v3
    v_lshl_add_u32 v221, v221, 4, v216
    v_add_u32 v221, s41, v221
    v_exp_f32 v128, v128
    v_exp_f32 v129, v129
    v_exp_f32 v130, v130
    v_exp_f32 v131, v131
    s_waitcnt vmcnt(14)
    v_smfmac_f32_32x32x32_bf16 v[40:55], v[160:163], v[120:127], v2
    v_exp_f32 v132, v132
    v_exp_f32 v133, v133
    v_exp_f32 v134, v134
    v_exp_f32 v135, v135
    v_mfma_f32_32x32x16_bf16 v[104:119], v[152:155], v[24:27], 0
    v_exp_f32 v136, v136
    v_exp_f32 v137, v137
    v_exp_f32 v138, v138
    v_exp_f32 v139, v139
    v_mfma_f32_32x32x16_bf16 v[104:119], v[156:159], v[28:31], v[104:119]
    v_exp_f32 v140, v140
    v_exp_f32 v141, v141
    v_exp_f32 v142, v142
    v_exp_f32 v143, v143
    v_smfmac_f32_32x32x32_bf16 v[40:55], v[164:167], v[128:135], v2
    v_lshrrev_b32 v1, 2, v0
    v_mul_u32_u24 v1, 896, v1
    v_and_or_b32 v1, v6, 48, v1
    s_and_b32 s43, s40, 3
    s_lshl_b32 s42, s43, 10
    s_add_u32 m0, s42, 149504
    s_mul_i32 s41, s43, 14336
    s_add_u32 s41, s41, s101
    buffer_load_dwordx4 v1, s[28:31], s41 offen  lds
    s_add_u32 s43, s43, 4
    s_min_u32 s43, s43, 6
    s_lshl_b32 s42, s43, 10
    s_add_u32 m0, s42, 149504
    s_mul_i32 s41, s43, 14336
    s_add_u32 s41, s41, s101
    buffer_load_dwordx4 v1, s[28:31], s41 offen  lds
    s_lshr_b32 s41, s2, 3
    s_mul_i32 s41, s41, 12544
    s_and_b32 s42, s40, 3
    s_mul_i32 s42, s42, 3200
    s_add_u32 s41, s41, s42
    v_min_u32 v246, 24, v0
    v_lshlrev_b32 v246, 7, v246
    buffer_load_dword v249, v246, s[16:19], s41 offen
    s_waitcnt vmcnt(7) lgkmcnt(0)
    v_and_b32 v222, v222, v223
    v_and_b32 v224, v224, v225
    v_and_b32 v222, v222, v224
    v_cmp_eq_u32 vcc, 0, v222
    s_cbranch_vccnz RETRY_92
OK_94:
    ds_read_b128 v[222:225], v220 offset:0
    ds_read_b64_tr_b16 v[226:227], v221 offset:0
    ds_read_b64_tr_b16 v[228:229], v221 offset:256
    ds_read_b128 v[230:233], v220 offset:64
    ds_read_b64_tr_b16 v[234:235], v221 offset:2048
    ds_read_b64_tr_b16 v[236:237], v221 offset:2304
    ds_read_b128 v[238:241], v220 offset:128
    ds_read_b64_tr_b16 v[242:243], v221 offset:4096
    ds_read_b64_tr_b16 v[244:245], v221 offset:4352
    v_exp_f32 v144, v144
    v_exp_f32 v145, v145
    v_exp_f32 v146, v146
    v_exp_f32 v147, v147
    v_smfmac_f32_32x32x32_bf16 v[56:71], v[160:163], v[136:143], v2
    v_exp_f32 v148, v148
    v_exp_f32 v149, v149
    v_exp_f32 v150, v150
    v_exp_f32 v151, v151
    v_mfma_f32_32x32x16_bf16 v[120:135], v[152:155], v[32:35], 0
    v_exp_f32 v104, v104
    v_exp_f32 v105, v105
    v_exp_f32 v106, v106
    v_exp_f32 v107, v107
    v_mfma_f32_32x32x16_bf16 v[120:135], v[156:159], v[36:39], v[120:135]
    v_exp_f32 v108, v108
    v_exp_f32 v109, v109
    v_exp_f32 v110, v110
    v_exp_f32 v111, v111
    v_smfmac_f32_32x32x32_bf16 v[56:71], v[164:167], v[144:151], v2
    s_waitcnt lgkmcnt(0)
    v_mfma_f32_16x16x32_bf16 v[216:219], v[222:225], v[226:229], 0
    ds_read_b128 v[222:225], v220 offset:192
    ds_read_b64_tr_b16 v[226:227], v221 offset:6144
    ds_read_b64_tr_b16 v[228:229], v221 offset:6400
    v_mfma_f32_16x16x32_bf16 v[216:219], v[230:233], v[234:237], v[216:219]
    ds_read_b128 v[230:233], v220 offset:256
    ds_read_b64_tr_b16 v[234:235], v221 offset:8192
    ds_read_b64_tr_b16 v[236:237], v221 offset:8448
    v_mfma_f32_16x16x32_bf16 v[216:219], v[238:241], v[242:245], v[216:219]
    ds_read_b128 v[238:241], v220 offset:320
    ds_read_b64_tr_b16 v[242:243], v221 offset:10240
    ds_read_b64_tr_b16 v[244:245], v221 offset:10496
    v_exp_f32 v112, v112
    v_exp_f32 v113, v113
    v_exp_f32 v114, v114
    v_exp_f32 v115, v115
    v_smfmac_f32_32x32x32_bf16 v[72:87], v[160:163], v[104:111], v2
    v_exp_f32 v116, v116
    v_exp_f32 v117, v117
    v_exp_f32 v118, v118
    v_exp_f32 v119, v119
    s_waitcnt vmcnt(15)
    v_mfma_f32_32x32x16_bf16 v[136:151], v[168:171], v[8:11], 0
    v_exp_f32 v120, v120
    v_exp_f32 v121, v121
    v_exp_f32 v122, v122
    v_exp_f32 v123, v123
    v_mfma_f32_32x32x16_bf16 v[136:151], v[172:175], v[12:15], v[136:151]
    v_exp_f32 v124, v124
    v_exp_f32 v125, v125
    v_exp_f32 v126, v126
    v_exp_f32 v127, v127
    v_smfmac_f32_32x32x32_bf16 v[72:87], v[164:167], v[112:119], v2
    s_waitcnt lgkmcnt(0)
    v_mfma_f32_16x16x32_bf16 v[216:219], v[222:225], v[226:229], v[216:219]
    ds_read_b128 v[222:225], v220 offset:384
    ds_read_b64_tr_b16 v[226:227], v221 offset:12288
    ds_read_b64_tr_b16 v[228:229], v221 offset:12544
    v_mfma_f32_16x16x32_bf16 v[216:219], v[230:233], v[234:237], v[216:219]
    v_mfma_f32_16x16x32_bf16 v[216:219], v[238:241], v[242:245], v[216:219]
    v_exp_f32 v128, v128
    v_exp_f32 v129, v129
    v_exp_f32 v130, v130
    v_exp_f32 v131, v131
    v_smfmac_f32_32x32x32_bf16 v[88:103], v[160:163], v[120:127], v2
    v_exp_f32 v132, v132
    v_exp_f32 v133, v133
    v_exp_f32 v134, v134
    v_exp_f32 v135, v135
    s_waitcnt vmcnt(10)
    v_mfma_f32_32x32x16_bf16 v[104:119], v[184:187], v[8:11], 0
    v_exp_f32 v136, v136
    v_exp_f32 v137, v137
    v_exp_f32 v138, v138
    v_exp_f32 v139, v139
    v_mfma_f32_32x32x16_bf16 v[104:119], v[188:191], v[12:15], v[104:119]
    v_exp_f32 v140, v140
    v_exp_f32 v141, v141
    v_exp_f32 v142, v142
    v_exp_f32 v143, v143
    v_smfmac_f32_32x32x32_bf16 v[88:103], v[164:167], v[128:135], v2
    s_waitcnt lgkmcnt(0)
    v_mfma_f32_16x16x32_bf16 v[216:219], v[222:225], v[226:229], v[216:219]
    v_exp_f32 v144, v144
    v_exp_f32 v145, v145
    v_exp_f32 v146, v146
    v_exp_f32 v147, v147
    s_waitcnt vmcnt(13)
    v_smfmac_f32_32x32x32_bf16 v[40:55], v[176:179], v[136:143], v2
    v_exp_f32 v148, v148
    v_exp_f32 v149, v149
    v_exp_f32 v150, v150
    v_exp_f32 v151, v151
    s_waitcnt vmcnt(5)
    v_mfma_f32_32x32x16_bf16 v[120:135], v[200:203], v[8:11], 0
    v_exp_f32 v104, v104
    v_exp_f32 v105, v105
    v_exp_f32 v106, v106
    v_exp_f32 v107, v107
    v_mfma_f32_32x32x16_bf16 v[120:135], v[204:207], v[12:15], v[120:135]
    v_exp_f32 v108, v108
    v_exp_f32 v109, v109
    v_exp_f32 v110, v110
    v_exp_f32 v111, v111
    v_smfmac_f32_32x32x32_bf16 v[40:55], v[180:183], v[144:151], v2
    s_mov_b64 exec, s[72:73]
    s_add_u32 m0, s78, s79
    s_lshl2_add_u32 s41, s79, s99
    buffer_load_dwordx4 v253, s[16:19], s41 offen lds
    s_add_u32 s41, s41, 2688
    buffer_load_dwordx4 v253, s[16:19], s41 offen offset:896 lds
    s_add_u32 s79, s79, 1792
    s_cmp_lt_u32 s79, 12544
    s_cselect_b32 s79, s79, 0
    s_mov_b64 exec, -1
    s_and_b32 s41, s63, 10
    s_cmp_eq_u32 s41, 0
    s_cbranch_scc1 SIDE_95
BACK_96:
    v_exp_f32 v112, v112
    v_exp_f32 v113, v113
    v_exp_f32 v114, v114
    v_exp_f32 v115, v115
    s_waitcnt vmcnt(10)
    v_smfmac_f32_32x32x32_bf16 v[40:55], v[192:195], v[104:111], v2
    v_exp_f32 v116, v116
    v_exp_f32 v117, v117
    v_exp_f32 v118, v118
    v_exp_f32 v119, v119
    v_mfma_f32_32x32x16_bf16 v[136:151], v[168:171], v[16:19], 0
    v_exp_f32 v120, v120
    v_exp_f32 v121, v121
    v_exp_f32 v122, v122
    v_exp_f32 v123, v123
    v_mfma_f32_32x32x16_bf16 v[136:151], v[172:175], v[20:23], v[136:151]
    v_exp_f32 v124, v124
    v_exp_f32 v125, v125
    v_exp_f32 v126, v126
    v_exp_f32 v127, v127
    v_smfmac_f32_32x32x32_bf16 v[40:55], v[196:199], v[112:119], v2
    s_mov_b64 exec, s[72:73]
    s_add_u32 m0, s78, s79
    s_lshl2_add_u32 s41, s79, s99
    buffer_load_dwordx4 v253, s[16:19], s41 offen lds
    s_add_u32 s41, s41, 2688
    buffer_load_dwordx4 v253, s[16:19], s41 offen offset:896 lds
    s_add_u32 s79, s79, 1792
    s_cmp_lt_u32 s79, 12544
    s_cselect_b32 s79, s79, 0
    s_mov_b64 exec, -1
    v_exp_f32 v128, v128
    v_exp_f32 v129, v129
    v_exp_f32 v130, v130
    v_exp_f32 v131, v131
    s_waitcnt vmcnt(7)
    v_smfmac_f32_32x32x32_bf16 v[40:55], v[208:211], v[120:127], v2
    v_exp_f32 v132, v132
    v_exp_f32 v133, v133
    v_exp_f32 v134, v134
    v_exp_f32 v135, v135
    v_mfma_f32_32x32x16_bf16 v[104:119], v[184:187], v[16:19], 0
    v_exp_f32 v136, v136
    v_exp_f32 v137, v137
    v_exp_f32 v138, v138
    v_exp_f32 v139, v139
    v_mfma_f32_32x32x16_bf16 v[104:119], v[188:191], v[20:23], v[104:119]
    v_exp_f32 v140, v140
    v_exp_f32 v141, v141
    v_exp_f32 v142, v142
    v_exp_f32 v143, v143
    v_smfmac_f32_32x32x32_bf16 v[40:55], v[212:215], v[128:135], v2
    s_mov_b64 exec, s[72:73]
    s_add_u32 m0, s78, s79
    s_lshl2_add_u32 s41, s79, s99
    buffer_load_dwordx4 v253, s[16:19], s41 offen lds
    s_add_u32 s41, s41, 2688
    buffer_load_dwordx4 v253, s[16:19], s41 offen offset:896 lds
    s_add_u32 s79, s79, 1792
    s_cmp_lt_u32 s79, 12544
    s_cselect_b32 s79, s79, 0
    s_mov_b64 exec, -1
    v_exp_f32 v144, v144
    v_exp_f32 v145, v145
    v_exp_f32 v146, v146
    v_exp_f32 v147, v147
    v_smfmac_f32_32x32x32_bf16 v[56:71], v[176:179], v[136:143], v2
    v_exp_f32 v148, v148
    v_exp_f32 v149, v149
    v_exp_f32 v150, v150
    v_exp_f32 v151, v151
    v_mfma_f32_32x32x16_bf16 v[120:135], v[200:203], v[16:19], 0
    v_exp_f32 v104, v104
    v_exp_f32 v105, v105
    v_exp_f32 v106, v106
    v_exp_f32 v107, v107
    v_add_u32 v232, s65, v6
    ds_write_b128 v232, v[40:43] offset:0
    v_mfma_f32_32x32x16_bf16 v[120:135], v[204:207], v[20:23], v[120:135]
    v_exp_f32 v108, v108
    v_exp_f32 v109, v109
    v_exp_f32 v110, v110
    v_exp_f32 v111, v111
    ds_write_b128 v232, v[44:47] offset:1024
    v_smfmac_f32_32x32x32_bf16 v[56:71], v[180:183], v[144:151], v2
    s_mov_b64 exec, s[72:73]
    s_add_u32 m0, s78, s79
    s_lshl2_add_u32 s41, s79, s99
    buffer_load_dwordx4 v253, s[16:19], s41 offen lds
    s_add_u32 s41, s41, 2688
    buffer_load_dwordx4 v253, s[16:19], s41 offen offset:896 lds
    s_add_u32 s79, s79, 1792
    s_cmp_lt_u32 s79, 12544
    s_cselect_b32 s79, s79, 0
    s_mov_b64 exec, -1
    v_exp_f32 v112, v112
    v_exp_f32 v113, v113
    v_exp_f32 v114, v114
    v_exp_f32 v115, v115
    ds_write_b128 v232, v[48:51] offset:2048
    v_smfmac_f32_32x32x32_bf16 v[56:71], v[192:195], v[104:111], v2
    v_exp_f32 v116, v116
    v_exp_f32 v117, v117
    v_exp_f32 v118, v118
    v_exp_f32 v119, v119
    ds_write_b128 v232, v[52:55] offset:3072
    s_setprio 0
    v_mfma_f32_32x32x16_bf16 v[136:151], v[168:171], v[24:27], 0
    v_exp_f32 v120, v120
    v_exp_f32 v121, v121
    v_exp_f32 v122, v122
    v_exp_f32 v123, v123
    v_mfma_f32_32x32x16_bf16 v[136:151], v[172:175], v[28:31], v[136:151]
    v_exp_f32 v124, v124
    v_exp_f32 v125, v125
    v_exp_f32 v126, v126
    v_exp_f32 v127, v127
    v_smfmac_f32_32x32x32_bf16 v[56:71], v[196:199], v[112:119], v2
    s_mov_b64 exec, s[72:73]
    s_add_u32 m0, s78, s79
    s_lshl2_add_u32 s41, s79, s99
    buffer_load_dwordx4 v253, s[16:19], s41 offen lds
    s_add_u32 s41, s41, 2688
    buffer_load_dwordx4 v253, s[16:19], s41 offen offset:896 lds
    s_add_u32 s79, s79, 1792
    s_cmp_lt_u32 s79, 12544
    s_cselect_b32 s79, s79, 0
    s_mov_b64 exec, -1
    s_and_b32 s41, s40, 3
    s_lshl2_add_u32 s41, s41, 157776
    v_mov_b32 v1, s41
    s_waitcnt vmcnt(10)
    ds_write_b32 v1, v2
    v_exp_f32 v128, v128
    v_exp_f32 v129, v129
    v_exp_f32 v130, v130
    v_exp_f32 v131, v131
    v_smfmac_f32_32x32x32_bf16 v[56:71], v[208:211], v[120:127], v2
    v_exp_f32 v132, v132
    v_exp_f32 v133, v133
    v_exp_f32 v134, v134
    v_exp_f32 v135, v135
    s_setprio 1
    v_mfma_f32_32x32x16_bf16 v[104:119], v[184:187], v[24:27], 0
    v_exp_f32 v136, v136
    v_exp_f32 v137, v137
    v_exp_f32 v138, v138
    v_exp_f32 v139, v139
    v_mfma_f32_32x32x16_bf16 v[104:119], v[188:191], v[28:31], v[104:119]
    v_exp_f32 v140, v140
    v_exp_f32 v141, v141
    v_exp_f32 v142, v142
    v_exp_f32 v143, v143
    v_smfmac_f32_32x32x32_bf16 v[56:71], v[212:215], v[128:135], v2
    s_mov_b64 exec, s[72:73]
    s_add_u32 m0, s78, s79
    s_lshl2_add_u32 s41, s79, s99
    buffer_load_dwordx4 v253, s[16:19], s41 offen lds
    s_add_u32 s41, s41, 2688
    buffer_load_dwordx4 v253, s[16:19], s41 offen offset:896 lds
    s_add_u32 s79, s79, 1792
    s_cmp_lt_u32 s79, 12544
    s_cselect_b32 s79, s79, 0
    s_mov_b64 exec, -1
    v_add_u32 v232, s66, v6
    ds_read_b128 v[228:231], v232 offset:3072
    ds_read_b128 v[216:219], v232 offset:0
    ds_read_b128 v[220:223], v232 offset:1024
    ds_read_b128 v[224:227], v232 offset:2048
    v_exp_f32 v144, v144
    v_exp_f32 v145, v145
    v_exp_f32 v146, v146
    v_exp_f32 v147, v147
    v_smfmac_f32_32x32x32_bf16 v[72:87], v[176:179], v[136:143], v2
    v_exp_f32 v148, v148
    v_exp_f32 v149, v149
    v_exp_f32 v150, v150
    v_exp_f32 v151, v151
    v_mfma_f32_32x32x16_bf16 v[120:135], v[200:203], v[24:27], 0
    v_exp_f32 v104, v104
    v_exp_f32 v105, v105
    v_exp_f32 v106, v106
    v_exp_f32 v107, v107
    s_waitcnt lgkmcnt(0)
    v_cmp_gt_f32 vcc, 0.5, v231
    s_nop 0
    s_andn2_b64 vcc, vcc, s[54:55]
    s_cbranch_vccnz RETRY_97
OK_99:
    v_pk_add_f32 v[56:57], v[56:57], v[216:217]
    v_pk_add_f32 v[58:59], v[58:59], v[218:219]
    v_pk_add_f32 v[60:61], v[60:61], v[220:221]
    v_pk_add_f32 v[62:63], v[62:63], v[222:223]
    v_pk_add_f32 v[64:65], v[64:65], v[224:225]
    v_pk_add_f32 v[66:67], v[66:67], v[226:227]
    v_pk_add_f32 v[68:69], v[68:69], v[228:229]
    v_pk_add_f32 v[70:71], v[70:71], v[230:231]
    ds_write_b128 v232, v[56:59] offset:0
    v_mfma_f32_32x32x16_bf16 v[120:135], v[204:207], v[28:31], v[120:135]
    v_exp_f32 v108, v108
    v_exp_f32 v109, v109
    v_exp_f32 v110, v110
    v_exp_f32 v111, v111
    ds_write_b128 v232, v[60:63] offset:1024
    v_smfmac_f32_32x32x32_bf16 v[72:87], v[180:183], v[144:151], v2
    s_mov_b64 exec, s[72:73]
    s_add_u32 m0, s78, s79
    s_lshl2_add_u32 s41, s79, s99
    buffer_load_dwordx4 v253, s[16:19], s41 offen lds
    s_add_u32 s41, s41, 2688
    buffer_load_dwordx4 v253, s[16:19], s41 offen offset:896 lds
    s_add_u32 s79, s79, 1792
    s_cmp_lt_u32 s79, 12544
    s_cselect_b32 s79, s79, 0
    s_mov_b64 exec, -1
    v_exp_f32 v112, v112
    v_exp_f32 v113, v113
    v_exp_f32 v114, v114
    v_exp_f32 v115, v115
    ds_write_b128 v232, v[64:67] offset:2048
    v_smfmac_f32_32x32x32_bf16 v[72:87], v[192:195], v[104:111], v2
    v_exp_f32 v116, v116
    v_exp_f32 v117, v117
    v_exp_f32 v118, v118
    v_exp_f32 v119, v119
    ds_write_b128 v232, v[68:71] offset:3072
    s_setprio 0
    v_mfma_f32_32x32x16_bf16 v[136:151], v[168:171], v[32:35], 0
    v_exp_f32 v120, v120
    v_exp_f32 v121, v121
    v_exp_f32 v122, v122
    v_exp_f32 v123, v123
    v_mfma_f32_32x32x16_bf16 v[136:151], v[172:175], v[36:39], v[136:151]
    v_exp_f32 v124, v124
    v_exp_f32 v125, v125
    v_exp_f32 v126, v126
    v_exp_f32 v127, v127
    v_smfmac_f32_32x32x32_bf16 v[72:87], v[196:199], v[112:119], v2
    s_and_b32 s41, s40, 3
    s_lshl2_add_u32 s41, s38, s41
    s_lshl4_add_u32 s41, s41, s39
    s_and_b32 s42, s39, 3
    s_mul_i32 s42, s42, 896
    s_mul_i32 s43, s41, 1792
    s_sub_u32 s42, s43, s42
    s_add_u32 s74, s42, 5242880
    s_lshl_b32 s41, s41, 7
    s_add_u32 s75, s41, 327680
    v_and_b32 v7, 16, v0
    v_mul_u32_u24 v7, 216, v7
    v_lshl_add_u32 v7, v4, 3, v7
    v_lshl_add_u32 v7, v5, 7, v7
    v_exp_f32 v128, v128
    v_exp_f32 v129, v129
    v_exp_f32 v130, v130
    v_exp_f32 v131, v131
    v_smfmac_f32_32x32x32_bf16 v[72:87], v[208:211], v[120:127], v2
    v_exp_f32 v132, v132
    v_exp_f32 v133, v133
    v_exp_f32 v134, v134
    v_exp_f32 v135, v135
    v_mfma_f32_32x32x16_bf16 v[104:119], v[184:187], v[32:35], 0
    v_exp_f32 v136, v136
    v_exp_f32 v137, v137
    v_exp_f32 v138, v138
    v_exp_f32 v139, v139
    v_mfma_f32_32x32x16_bf16 v[104:119], v[188:191], v[36:39], v[104:119]
    v_exp_f32 v140, v140
    v_exp_f32 v141, v141
    v_exp_f32 v142, v142
    v_exp_f32 v143, v143
    v_smfmac_f32_32x32x32_bf16 v[72:87], v[212:215], v[128:135], v2
    v_add_u32 v232, s67, v6
    ds_read_b128 v[228:231], v232 offset:3072
    ds_read_b128 v[216:219], v232 offset:0
    ds_read_b128 v[220:223], v232 offset:1024
    ds_read_b128 v[224:227], v232 offset:2048
    v_exp_f32 v144, v144
    v_exp_f32 v145, v145
    v_exp_f32 v146, v146
    v_exp_f32 v147, v147
    v_smfmac_f32_32x32x32_bf16 v[88:103], v[176:179], v[136:143], v2
    v_exp_f32 v148, v148
    v_exp_f32 v149, v149
    v_exp_f32 v150, v150
    v_exp_f32 v151, v151
    s_setprio 1
    v_mfma_f32_32x32x16_bf16 v[120:135], v[200:203], v[32:35], 0
    v_exp_f32 v104, v104
    v_exp_f32 v105, v105
    v_exp_f32 v106, v106
    v_exp_f32 v107, v107
    s_waitcnt lgkmcnt(0)
    v_cmp_gt_f32 vcc, 0x3fc00000, v231
    s_nop 0
    s_andn2_b64 vcc, vcc, s[54:55]
    s_cbranch_vccnz RETRY_100
OK_102:
    v_pk_add_f32 v[72:73], v[72:73], v[216:217]
    v_pk_add_f32 v[74:75], v[74:75], v[218:219]
    v_pk_add_f32 v[76:77], v[76:77], v[220:221]
    v_pk_add_f32 v[78:79], v[78:79], v[222:223]
    v_pk_add_f32 v[80:81], v[80:81], v[224:225]
    v_pk_add_f32 v[82:83], v[82:83], v[226:227]
    v_pk_add_f32 v[84:85], v[84:85], v[228:229]
    v_pk_add_f32 v[86:87], v[86:87], v[230:231]
    ds_write_b128 v232, v[72:75] offset:0
    v_mfma_f32_32x32x16_bf16 v[120:135], v[204:207], v[36:39], v[120:135]
    v_exp_f32 v108, v108
    v_exp_f32 v109, v109
    v_exp_f32 v110, v110
    v_exp_f32 v111, v111
    ds_write_b128 v232, v[76:79] offset:1024
    v_smfmac_f32_32x32x32_bf16 v[88:103], v[180:183], v[144:151], v2
    s_lshl2_add_u32 s41, s40, 157792
    v_mov_b32 v1, s41
    s_waitcnt vmcnt(0)
    ds_write_b32 v1, v2
    v_exp_f32 v112, v112
    v_exp_f32 v113, v113
    v_exp_f32 v114, v114
    v_exp_f32 v115, v115
    ds_write_b128 v232, v[80:83] offset:2048
    v_smfmac_f32_32x32x32_bf16 v[88:103], v[192:195], v[104:111], v2
    v_exp_f32 v116, v116
    v_exp_f32 v117, v117
    v_exp_f32 v118, v118
    v_exp_f32 v119, v119
    ds_write_b128 v232, v[84:87] offset:3072
    v_exp_f32 v120, v120
    v_exp_f32 v121, v121
    v_exp_f32 v122, v122
    v_exp_f32 v123, v123
    v_exp_f32 v124, v124
    v_exp_f32 v125, v125
    v_exp_f32 v126, v126
    v_exp_f32 v127, v127
    v_smfmac_f32_32x32x32_bf16 v[88:103], v[196:199], v[112:119], v2
    v_add_u32 v232, s68, v6
    ds_read_b128 v[228:231], v232 offset:3072
    ds_read_b128 v[216:219], v232 offset:0
    ds_read_b128 v[220:223], v232 offset:1024
    ds_read_b128 v[224:227], v232 offset:2048
    v_exp_f32 v128, v128
    v_exp_f32 v129, v129
    v_exp_f32 v130, v130
    v_exp_f32 v131, v131
    v_smfmac_f32_32x32x32_bf16 v[88:103], v[208:211], v[120:127], v2
    v_subrev_u32 v233, 16384, v232
    ds_read_b128 v[52:55], v233 offset:3072
    ds_read_b128 v[40:43], v233 offset:0
    ds_read_b128 v[44:47], v233 offset:1024
    ds_read_b128 v[48:51], v233 offset:2048
    v_exp_f32 v132, v132
    v_exp_f32 v133, v133
    v_exp_f32 v134, v134
    v_exp_f32 v135, v135
    s_nop 1
    v_smfmac_f32_32x32x32_bf16 v[88:103], v[212:215], v[128:135], v2
    s_waitcnt lgkmcnt(4)
    v_cmp_gt_f32 vcc, 0x40200000, v231
    s_nop 0
    s_andn2_b64 vcc, vcc, s[54:55]
    s_cbranch_vccnz RETRY_103
OK_105:
    s_waitcnt lgkmcnt(0)
    v_cmp_gt_f32 vcc, 0x40600000, v55
    s_nop 0
    s_andn2_b64 vcc, vcc, s[54:55]
    s_cbranch_vccnz RETRY_106
OK_108:
    v_pk_add_f32 v[216:217], v[216:217], v[40:41]
    v_pk_add_f32 v[218:219], v[218:219], v[42:43]
    v_pk_add_f32 v[220:221], v[220:221], v[44:45]
    v_pk_add_f32 v[222:223], v[222:223], v[46:47]
    v_pk_add_f32 v[224:225], v[224:225], v[48:49]
    v_pk_add_f32 v[226:227], v[226:227], v[50:51]
    v_pk_add_f32 v[228:229], v[228:229], v[52:53]
    v_pk_add_f32 v[230:231], v[230:231], v[54:55]
    v_add_f32 v234, v100, v228
    v_add_f32 v235, v100, v228
    v_pk_add_f32 v[88:89], v[88:89], v[216:217]
    v_pk_add_f32 v[90:91], v[90:91], v[218:219]
    v_pk_add_f32 v[92:93], v[92:93], v[220:221]
    v_pk_add_f32 v[94:95], v[94:95], v[222:223]
    v_pk_add_f32 v[96:97], v[96:97], v[224:225]
    v_pk_add_f32 v[98:99], v[98:99], v[226:227]
    v_pk_add_f32 v[100:101], v[100:101], v[228:229]
    v_pk_add_f32 v[102:103], v[102:103], v[230:231]
    s_mov_b32 s46, 0
L_FBRET:
    s_nop 0
    v_permlane32_swap_b32 v235, v234
    v_rcp_f32 v236, v234
    v_rcp_f32 v237, v234
    s_nop 0
    v_pk_mul_f32 v[216:217], v[88:89], v[236:237]
    v_pk_mul_f32 v[218:219], v[90:91], v[236:237]
    v_cvt_pk_bf16_f32 v40, v216, v217
    v_cvt_pk_bf16_f32 v41, v218, v219
    buffer_store_dwordx2 v[40:41], v7, s[12:15], s74 offen offset:0 sc1
    v_pk_mul_f32 v[216:217], v[92:93], v[236:237]
    v_pk_mul_f32 v[218:219], v[94:95], v[236:237]
    v_cvt_pk_bf16_f32 v42, v216, v217
    v_cvt_pk_bf16_f32 v43, v218, v219
    buffer_store_dwordx2 v[42:43], v7, s[12:15], s74 offen offset:256 sc1
    v_pk_mul_f32 v[216:217], v[96:97], v[236:237]
    v_pk_mul_f32 v[218:219], v[98:99], v[236:237]
    v_cvt_pk_bf16_f32 v44, v216, v217
    v_cvt_pk_bf16_f32 v45, v218, v219
    buffer_store_dwordx2 v[44:45], v7, s[12:15], s74 offen offset:512 sc1
    v_pk_mul_f32 v[216:217], v[100:101], v[236:237]
    v_pk_mul_f32 v[218:219], v[102:103], v[236:237]
    v_cvt_pk_bf16_f32 v46, v216, v217
    v_cvt_pk_bf16_f32 v47, v218, v219
    s_mov_b64 exec, s[54:55]
    buffer_store_dwordx2 v[46:47], v7, s[12:15], s74 offen offset:768 sc1
    s_mov_b64 exec, -1
    ds_write_b32 v1, v2 offset:16
    v_fmac_f32 v234, 0, v88
    v_fmac_f32 v234, 0, v89
    v_fmac_f32 v234, 0, v90
    v_fmac_f32 v234, 0, v91
    v_fmac_f32 v234, 0, v92
    v_fmac_f32 v234, 0, v93
    v_fmac_f32 v234, 0, v94
    v_fmac_f32 v234, 0, v95
    v_fmac_f32 v234, 0, v96
    v_fmac_f32 v234, 0, v97
    v_fmac_f32 v234, 0, v98
    v_fmac_f32 v234, 0, v99
    v_fmac_f32 v234, 0, v100
    v_fmac_f32 v234, 0, v101
    v_fmac_f32 v234, 0, v102
    v_fmac_f32 v234, 0, v103
    v_cmp_nge_f32 vcc, 0x58800000, v234
    s_nop 0
    s_mov_b64 s[56:57], vcc
    v_cmp_nle_f32 vcc, 0x30800000, v234
    s_nop 0
    s_or_b64 vcc, vcc, s[56:57]
    s_cbranch_vccnz L_FB
L_FBSKIP:
L_P3:
    v_and_b32 v9, 28, v0
    v_add_u32 v9, 157792, v9
    ds_read_b32 v8, v9
    s_mov_b32 s10, 0x1c0000
    s_mov_b32 s11, 0x20000
    s_lshr_b32 s44, s40, 2
    s_and_b32 s45, s40, 3
    v_and_b32 v208, 15, v0
    v_lshl_add_u32 v205, s44, 4, v208
    v_bfe_u32 v209, v0, 4, 1
    v_lshl_add_u32 v209, v209, 1, v5
    v_lshl_add_u32 v206, s45, 2, v209
    v_cmp_gt_u32 vcc, 14, v206
    s_lshr_b32 s41, s39, 2
    s_lshl2_add_u32 s79, s38, s41
    s_mul_i32 s50, s79, 28672
    s_and_b32 s48, s39, 3
    s_mul_i32 s41, s48, 224
    s_add_u32 s50, s50, s41
    v_mul_u32_u24 v207, 896, v205
    v_lshl_add_u32 v207, v206, 4, v207
    v_bfrev_b32 v210, 2
    v_cndmask_b32 v207, v210, v207, vcc
    buffer_load_dwordx4 v[184:187], v207, s[4:7], s50 offen
    s_lshl_b32 s41, s79, 9
    s_add_u32 s41, s41, 32768
    v_lshlrev_b32 v210, 4, v205
    buffer_load_dwordx2 v[188:189], v210, s[12:15], s41 offen sc1
    v_lshrrev_b32 v210, 2, v0
    v_mul_u32_u24 v210, 224, v210
    v_and_b32 v211, 24, v3
    v_lshl_add_u32 v211, s45, 6, v211
    v_add_u32 v210, v211, v210
    v_add_u32 v211, 50176, v210
    s_mul_i32 s41, s44, 3584
    s_add_u32 s41, s41, 100352
    v_add_u32 v209, s41, v3
    s_lshl2_add_u32 s41, s79, s45
    s_mul_i32 s42, s41, 7168
    s_add_u32 s59, s42, 5242880
    s_lshl_b32 s41, s41, 9
    s_add_u32 s41, s41, 327680
    s_add_u32 s76, s12, s41
    s_addc_u32 s77, s13, 0
    s_mul_i32 s51, s45, 7168
    s_add_u32 s51, s51, 100352
    s_waitcnt lgkmcnt(0)
    v_cmp_eq_u32 vcc, 0, v8
    s_cbranch_vccnz RETRY_109
OK_111:
    s_load_dwordx2 s[8:9], s[0:1], 64
    s_load_dwordx4 s[68:71], s[12:13], 256
    ds_read_b64_tr_b16 v[8:9], v210 offset:0
    ds_read_b64_tr_b16 v[10:11], v210 offset:3584
    ds_read_b64_tr_b16 v[12:13], v210 offset:32
    ds_read_b64_tr_b16 v[14:15], v210 offset:3616
    ds_read_b64_tr_b16 v[16:17], v210 offset:7168
    ds_read_b64_tr_b16 v[18:19], v210 offset:10752
    ds_read_b64_tr_b16 v[20:21], v210 offset:7200
    ds_read_b64_tr_b16 v[22:23], v210 offset:10784
    ds_read_b64_tr_b16 v[24:25], v210 offset:14336
    ds_read_b64_tr_b16 v[26:27], v210 offset:17920
    ds_read_b64_tr_b16 v[28:29], v210 offset:14368
    ds_read_b64_tr_b16 v[30:31], v210 offset:17952
    ds_read_b64_tr_b16 v[32:33], v210 offset:21504
    ds_read_b64_tr_b16 v[34:35], v210 offset:25088
    ds_read_b64_tr_b16 v[36:37], v210 offset:21536
    ds_read_b64_tr_b16 v[38:39], v210 offset:25120
    s_cmp_lt_u32 s40, 4
    s_cbranch_scc1 L_NOOF
    s_waitcnt vmcnt(2)
    s_atomic_swap s36, s[12:13], s75
    s_setprio 0
L_NOOF:
    ds_read_b64_tr_b16 v[40:41], v210 offset:28672
    ds_read_b64_tr_b16 v[42:43], v210 offset:32256
    ds_read_b64_tr_b16 v[44:45], v210 offset:28704
    ds_read_b64_tr_b16 v[46:47], v210 offset:32288
    ds_read_b64_tr_b16 v[48:49], v210 offset:35840
    ds_read_b64_tr_b16 v[50:51], v210 offset:39424
    ds_read_b64_tr_b16 v[52:53], v210 offset:35872
    ds_read_b64_tr_b16 v[54:55], v210 offset:39456
    ds_read_b64_tr_b16 v[56:57], v210 offset:43008
    ds_read_b64_tr_b16 v[58:59], v210 offset:46592
    ds_read_b64_tr_b16 v[60:61], v210 offset:43040
    ds_read_b64_tr_b16 v[62:63], v210 offset:46624
    ds_read_b64_tr_b16 v[64:65], v211 offset:0
    ds_read_b64_tr_b16 v[66:67], v211 offset:3584
    ds_read_b64_tr_b16 v[68:69], v211 offset:32
    ds_read_b64_tr_b16 v[70:71], v211 offset:3616
    ds_read_b64_tr_b16 v[72:73], v211 offset:7168
    ds_read_b64_tr_b16 v[74:75], v211 offset:10752
    ds_read_b64_tr_b16 v[76:77], v211 offset:7200
    ds_read_b64_tr_b16 v[78:79], v211 offset:10784
    ds_read_b64_tr_b16 v[80:81], v211 offset:14336
    ds_read_b64_tr_b16 v[82:83], v211 offset:17920
    ds_read_b64_tr_b16 v[84:85], v211 offset:14368
    ds_read_b64_tr_b16 v[86:87], v211 offset:17952
    ds_read_b64_tr_b16 v[88:89], v211 offset:21504
    ds_read_b64_tr_b16 v[90:91], v211 offset:25088
    ds_read_b64_tr_b16 v[92:93], v211 offset:21536
    ds_read_b64_tr_b16 v[94:95], v211 offset:25120
    ds_read_b64_tr_b16 v[96:97], v211 offset:28672
    ds_read_b64_tr_b16 v[98:99], v211 offset:32256
    ds_read_b64_tr_b16 v[100:101], v211 offset:28704
    ds_read_b64_tr_b16 v[102:103], v211 offset:32288
    ds_read_b64_tr_b16 v[104:105], v211 offset:35840
    ds_read_b64_tr_b16 v[106:107], v211 offset:39424
    ds_read_b64_tr_b16 v[108:109], v211 offset:35872
    ds_read_b64_tr_b16 v[110:111], v211 offset:39456
    ds_read_b64_tr_b16 v[112:113], v211 offset:43008
    ds_read_b64_tr_b16 v[114:115], v211 offset:46592
    ds_read_b64_tr_b16 v[116:117], v211 offset:43040
    ds_read_b64_tr_b16 v[118:119], v211 offset:46624
    s_waitcnt lgkmcnt(0)
    s_cmp_lg_u32 s71, s36
    s_cselect_b64 vcc, -1, 0
    s_cbranch_vccnz RETRY_112
OK_114:
    s_lshl1_add_u32 s41, s79, 1
    s_lshr_b32 s42, s68, 4
    s_lshr_b32 s43, s69, 4
    s_cmp_eq_u32 s42, s41
    s_cselect_b32 s42, 0, 1
    s_cmp_eq_u32 s43, s41
    s_cselect_b32 s42, 0, s42
    s_cmp_eq_u32 s42, s44
    s_cbranch_scc1 SIDE_115
BACK_116:
    s_waitcnt vmcnt(0)
L_HAVEX:
    v_lshl_add_u32 v212, s79, 5, v205
    v_cmp_eq_u32 s[52:53], s68, v212
    v_cmp_eq_u32 s[72:73], s69, v212
    s_nop 0
    s_or_b64 vcc, s[52:53], s[72:73]
    s_cbranch_scc1 SIDE_123
BACK_124:
    v_lshlrev_b32 v196, 16, v184
    v_and_b32 v197, 0xffff0000, v184
    v_sub_f32 v196, v196, v188
    v_sub_f32 v197, v197, v188
    v_cvt_pk_bf16_f32 v213, v196, v197
    v_lshlrev_b32 v196, 16, v213
    v_and_b32 v197, 0xffff0000, v213
    v_mul_f32 v196, v196, v189
    v_mul_f32 v197, v197, v189
    v_cvt_pk_bf16_f32 v213, v196, v197
    v_lshlrev_b32 v196, 16, v213
    v_and_b32 v197, 0xffff0000, v213
    v_mul_f32 v213, 0xbfb8aa3b, v196
    v_mul_f32 v214, 0xbfb8aa3b, v197
    v_exp_f32 v213, v213
    v_exp_f32 v214, v214
    v_add_f32 v213, 1.0, v213
    v_add_f32 v214, 1.0, v214
    v_rcp_f32 v213, v213
    v_rcp_f32 v214, v214
    v_mul_f32 v196, v196, v213
    v_mul_f32 v197, v197, v214
    v_cvt_pk_bf16_f32 v213, v196, v197
    v_lshlrev_b32 v196, 16, v213
    v_and_b32 v197, 0xffff0000, v213
    v_lshlrev_b32 v198, 16, v185
    v_and_b32 v199, 0xffff0000, v185
    v_sub_f32 v198, v198, v188
    v_sub_f32 v199, v199, v188
    v_cvt_pk_bf16_f32 v213, v198, v199
    v_lshlrev_b32 v198, 16, v213
    v_and_b32 v199, 0xffff0000, v213
    v_mul_f32 v198, v198, v189
    v_mul_f32 v199, v199, v189
    v_cvt_pk_bf16_f32 v213, v198, v199
    v_lshlrev_b32 v198, 16, v213
    v_and_b32 v199, 0xffff0000, v213
    v_mul_f32 v213, 0xbfb8aa3b, v198
    v_mul_f32 v214, 0xbfb8aa3b, v199
    v_exp_f32 v213, v213
    v_exp_f32 v214, v214
    v_add_f32 v213, 1.0, v213
    v_add_f32 v214, 1.0, v214
    v_rcp_f32 v213, v213
    v_rcp_f32 v214, v214
    v_mul_f32 v198, v198, v213
    v_mul_f32 v199, v199, v214
    v_cvt_pk_bf16_f32 v213, v198, v199
    v_lshlrev_b32 v198, 16, v213
    v_and_b32 v199, 0xffff0000, v213
    v_lshlrev_b32 v200, 16, v186
    v_and_b32 v201, 0xffff0000, v186
    v_sub_f32 v200, v200, v188
    v_sub_f32 v201, v201, v188
    v_cvt_pk_bf16_f32 v213, v200, v201
    v_lshlrev_b32 v200, 16, v213
    v_and_b32 v201, 0xffff0000, v213
    v_mul_f32 v200, v200, v189
    v_mul_f32 v201, v201, v189
    v_cvt_pk_bf16_f32 v213, v200, v201
    v_lshlrev_b32 v200, 16, v213
    v_and_b32 v201, 0xffff0000, v213
    v_mul_f32 v213, 0xbfb8aa3b, v200
    v_mul_f32 v214, 0xbfb8aa3b, v201
    v_exp_f32 v213, v213
    v_exp_f32 v214, v214
    v_add_f32 v213, 1.0, v213
    v_add_f32 v214, 1.0, v214
    v_rcp_f32 v213, v213
    v_rcp_f32 v214, v214
    v_mul_f32 v200, v200, v213
    v_mul_f32 v201, v201, v214
    v_cvt_pk_bf16_f32 v213, v200, v201
    v_lshlrev_b32 v200, 16, v213
    v_and_b32 v201, 0xffff0000, v213
    v_lshlrev_b32 v202, 16, v187
    v_and_b32 v203, 0xffff0000, v187
    v_sub_f32 v202, v202, v188
    v_sub_f32 v203, v203, v188
    v_cvt_pk_bf16_f32 v213, v202, v203
    v_lshlrev_b32 v202, 16, v213
    v_and_b32 v203, 0xffff0000, v213
    v_mul_f32 v202, v202, v189
    v_mul_f32 v203, v203, v189
    v_cvt_pk_bf16_f32 v213, v202, v203
    v_lshlrev_b32 v202, 16, v213
    v_and_b32 v203, 0xffff0000, v213
    v_mul_f32 v213, 0xbfb8aa3b, v202
    v_mul_f32 v214, 0xbfb8aa3b, v203
    v_exp_f32 v213, v213
    v_exp_f32 v214, v214
    v_add_f32 v213, 1.0, v213
    v_add_f32 v214, 1.0, v214
    v_rcp_f32 v213, v213
    v_rcp_f32 v214, v214
    v_mul_f32 v202, v202, v213
    v_mul_f32 v203, v203, v214
    v_cvt_pk_bf16_f32 v213, v202, v203
    v_lshlrev_b32 v202, 16, v213
    v_and_b32 v203, 0xffff0000, v213
L_HAVEG:
    v_lshlrev_b32 v216, 16, v184
    v_and_b32 v217, 0xffff0000, v184
    v_lshlrev_b32 v218, 16, v185
    v_and_b32 v219, 0xffff0000, v185
    v_lshlrev_b32 v220, 16, v186
    v_and_b32 v221, 0xffff0000, v186
    v_lshlrev_b32 v222, 16, v187
    v_and_b32 v223, 0xffff0000, v187
    s_waitcnt vmcnt(0) lgkmcnt(0)
    s_barrier
    ds_read_b64 v[120:121], v209 offset:0
    ds_read_b64 v[122:123], v209 offset:512
    ds_read_b64 v[124:125], v209 offset:1024
    ds_read_b64 v[126:127], v209 offset:1536
    ds_read_b64 v[128:129], v209 offset:2048
    ds_read_b64 v[130:131], v209 offset:2560
    ds_read_b64 v[132:133], v209 offset:3072
    ds_read_b64 v[134:135], v209 offset:7168
    ds_read_b64 v[136:137], v209 offset:7680
    ds_read_b64 v[138:139], v209 offset:8192
    ds_read_b64 v[140:141], v209 offset:8704
    ds_read_b64 v[142:143], v209 offset:9216
    ds_read_b64 v[144:145], v209 offset:9728
    ds_read_b64 v[146:147], v209 offset:10240
    s_waitcnt lgkmcnt(12)
    v_mfma_f32_16x16x32_bf16 v[176:179], v[8:11], v[120:123], 0
    v_mfma_f32_16x16x32_bf16 v[180:183], v[12:15], v[120:123], 0
    ds_read_b64 v[148:149], v209 offset:14336
    ds_read_b64 v[150:151], v209 offset:14848
    s_waitcnt lgkmcnt(12)
    v_mfma_f32_16x16x32_bf16 v[176:179], v[16:19], v[124:127], v[176:179]
    v_mfma_f32_16x16x32_bf16 v[180:183], v[20:23], v[124:127], v[180:183]
    ds_read_b64 v[152:153], v209 offset:15360
    ds_read_b64 v[154:155], v209 offset:15872
    s_waitcnt lgkmcnt(12)
    v_mfma_f32_16x16x32_bf16 v[176:179], v[24:27], v[128:131], v[176:179]
    v_mfma_f32_16x16x32_bf16 v[180:183], v[28:31], v[128:131], v[180:183]
    ds_read_b64 v[156:157], v209 offset:16384
    ds_read_b64 v[158:159], v209 offset:16896
    s_waitcnt lgkmcnt(12)
    v_mfma_f32_16x16x32_bf16 v[176:179], v[32:35], v[132:135], v[176:179]
    v_mfma_f32_16x16x32_bf16 v[180:183], v[36:39], v[132:135], v[180:183]
    ds_read_b64 v[160:161], v209 offset:17408
    ds_read_b64 v[162:163], v209 offset:21504
    s_waitcnt lgkmcnt(12)
    v_mfma_f32_16x16x32_bf16 v[176:179], v[40:43], v[136:139], v[176:179]
    v_mfma_f32_16x16x32_bf16 v[180:183], v[44:47], v[136:139], v[180:183]
    ds_read_b64 v[164:165], v209 offset:22016
    ds_read_b64 v[166:167], v209 offset:22528
    s_waitcnt lgkmcnt(12)
    v_mfma_f32_16x16x32_bf16 v[176:179], v[48:51], v[140:143], v[176:179]
    v_mfma_f32_16x16x32_bf16 v[180:183], v[52:55], v[140:143], v[180:183]
    ds_read_b64 v[168:169], v209 offset:23040
    ds_read_b64 v[170:171], v209 offset:23552
    s_waitcnt lgkmcnt(12)
    v_mfma_f32_16x16x32_bf16 v[176:179], v[56:59], v[144:147], v[176:179]
    v_mfma_f32_16x16x32_bf16 v[180:183], v[60:63], v[144:147], v[180:183]
    ds_read_b64 v[172:173], v209 offset:24064
    ds_read_b64 v[174:175], v209 offset:24576
    s_waitcnt lgkmcnt(12)
    v_mfma_f32_16x16x32_bf16 v[176:179], v[64:67], v[148:151], v[176:179]
    v_mfma_f32_16x16x32_bf16 v[180:183], v[68:71], v[148:151], v[180:183]
    s_waitcnt lgkmcnt(10)
    v_mfma_f32_16x16x32_bf16 v[176:179], v[72:75], v[152:155], v[176:179]
    v_mfma_f32_16x16x32_bf16 v[180:183], v[76:79], v[152:155], v[180:183]
    s_waitcnt lgkmcnt(8)
    v_mfma_f32_16x16x32_bf16 v[176:179], v[80:83], v[156:159], v[176:179]
    v_mfma_f32_16x16x32_bf16 v[180:183], v[84:87], v[156:159], v[180:183]
    s_waitcnt lgkmcnt(6)
    v_mfma_f32_16x16x32_bf16 v[176:179], v[88:91], v[160:163], v[176:179]
    v_mfma_f32_16x16x32_bf16 v[180:183], v[92:95], v[160:163], v[180:183]
    s_waitcnt lgkmcnt(4)
    v_mfma_f32_16x16x32_bf16 v[176:179], v[96:99], v[164:167], v[176:179]
    v_mfma_f32_16x16x32_bf16 v[180:183], v[100:103], v[164:167], v[180:183]
    s_waitcnt lgkmcnt(2)
    v_mfma_f32_16x16x32_bf16 v[176:179], v[104:107], v[168:171], v[176:179]
    v_mfma_f32_16x16x32_bf16 v[180:183], v[108:111], v[168:171], v[180:183]
    s_waitcnt lgkmcnt(0)
    v_mfma_f32_16x16x32_bf16 v[176:179], v[112:115], v[172:175], v[176:179]
    v_mfma_f32_16x16x32_bf16 v[180:183], v[116:119], v[172:175], v[180:183]
    s_nop 6
    v_cvt_pk_bf16_f32 v184, v176, v177
    v_cvt_pk_bf16_f32 v186, v180, v181
    v_cvt_pk_bf16_f32 v185, v178, v179
    v_cvt_pk_bf16_f32 v187, v182, v183
    v_permlane16_swap_b32 v184, v186
    s_nop 0
    v_permlane16_swap_b32 v185, v187
    v_lshlrev_b32 v176, 16, v184
    v_and_b32 v177, 0xffff0000, v184
    v_lshlrev_b32 v178, 16, v185
    v_and_b32 v179, 0xffff0000, v185
    v_lshlrev_b32 v180, 16, v186
    v_and_b32 v181, 0xffff0000, v186
    v_lshlrev_b32 v182, 16, v187
    v_and_b32 v183, 0xffff0000, v187
    v_mul_f32 v176, v176, v196
    v_mul_f32 v177, v177, v197
    v_mul_f32 v178, v178, v198
    v_mul_f32 v179, v179, v199
    v_mul_f32 v180, v180, v200
    v_mul_f32 v181, v181, v201
    v_mul_f32 v182, v182, v202
    v_mul_f32 v183, v183, v203
    v_cvt_pk_bf16_f32 v184, v176, v177
    v_cvt_pk_bf16_f32 v185, v178, v179
    v_cvt_pk_bf16_f32 v186, v180, v181
    v_cvt_pk_bf16_f32 v187, v182, v183
    v_lshlrev_b32 v176, 16, v184
    v_and_b32 v177, 0xffff0000, v184
    v_lshlrev_b32 v178, 16, v185
    v_and_b32 v179, 0xffff0000, v185
    v_lshlrev_b32 v180, 16, v186
    v_and_b32 v181, 0xffff0000, v186
    v_lshlrev_b32 v182, 16, v187
    v_and_b32 v183, 0xffff0000, v187
    v_add_f32 v176, v176, v216
    v_add_f32 v177, v177, v217
    v_add_f32 v178, v178, v218
    v_add_f32 v179, v179, v219
    v_add_f32 v180, v180, v220
    v_add_f32 v181, v181, v221
    v_add_f32 v182, v182, v222
    v_add_f32 v183, v183, v223
    v_cvt_pk_bf16_f32 v184, v176, v177
    v_cvt_pk_bf16_f32 v185, v178, v179
    v_cvt_pk_bf16_f32 v186, v180, v181
    v_cvt_pk_bf16_f32 v187, v182, v183
    buffer_store_dwordx4 v[184:187], v207, s[8:11], s50 offen
    s_or_b32 s41, s2, s40
    s_cbranch_scc0 L_W7END
L_FIN:
    s_endpgm
L_W7END:
    s_mov_b32 s46, 0
    v_mov_b32 v212, s36
    v_mov_b32 v213, s36
    s_mov_b64 exec, 0xffff
    s_nop 0
    buffer_store_dwordx2 v[212:213], v3, s[12:15], s46 offen sc1
    s_mov_b64 exec, -1
    s_branch L_FIN
RETRY_1:
    s_mov_b32 s58, 200000
RETRYL_2:
    buffer_load_dwordx4 v[64:67], v126, s[12:15], s71 offen sc1
    s_sub_u32 s58, s58, 1
    s_cbranch_scc1 OK_3x
    s_waitcnt vmcnt(0)
    v_cmp_ne_u32 vcc, s36, v67
    s_cbranch_vccnz RETRYL_2
OK_3x:
    s_waitcnt vmcnt(0)
    s_branch OK_3
SIDE_4:
    v_mov_b32 v144, 157952
    ds_read_b128 v[128:131], v144
    ds_read_b128 v[132:135], v144 offset:16
    s_waitcnt lgkmcnt(0)
    v_med3_u32 v129, v128, v129, v130
    v_max_u32 v128, v128, v130
    v_med3_u32 v129, v128, v129, v131
    v_max_u32 v128, v128, v131
    v_med3_u32 v129, v128, v129, v132
    v_max_u32 v128, v128, v132
    v_med3_u32 v129, v128, v129, v133
    v_max_u32 v128, v128, v133
    v_med3_u32 v129, v128, v129, v134
    v_max_u32 v128, v128, v134
    v_med3_u32 v129, v128, v129, v135
    v_max_u32 v128, v128, v135
    s_nop 0
    v_readfirstlane_b32 s49, v128
    v_readfirstlane_b32 s50, v129
    s_and_b32 s49, s49, 0x7ff
    s_sub_u32 s49, 0x7ff, s49
    s_and_b32 s50, s50, 0x7ff
    s_sub_u32 s50, 0x7ff, s50
    v_min_u32 v144, 55, v0
    v_lshlrev_b32 v144, 4, v144
    v_mov_b32 v145, 32768
    s_mul_i32 s41, s49, 896
    buffer_load_dwordx4 v[128:131], v144, s[4:7], s41 offen
    s_lshl_b32 s41, s49, 4
    buffer_load_dwordx4 v[136:139], v145, s[12:15], s41 offen sc1
    s_mul_i32 s41, s50, 896
    buffer_load_dwordx4 v[132:135], v144, s[4:7], s41 offen
    s_lshl_b32 s41, s50, 4
    buffer_load_dwordx4 v[140:143], v145, s[12:15], s41 offen sc1
    s_branch BACK_5
SIDE_6:
    s_lshl_b32 s41, s40, 6
    v_add_u32 v128, s41, v0
    v_lshlrev_b32 v129, 4, v128
    s_waitcnt vmcnt(0)
    s_mov_b32 s41, 32776
    buffer_load_dwordx2 v[130:131], v129, s[12:15], s41 offen sc1
    s_mov_b32 s41, 36872
    buffer_load_dwordx2 v[132:133], v129, s[12:15], s41 offen sc1
    s_mov_b32 s41, 40968
    buffer_load_dwordx2 v[134:135], v129, s[12:15], s41 offen sc1
    s_mov_b32 s41, 45064
    buffer_load_dwordx2 v[136:137], v129, s[12:15], s41 offen sc1
    s_mov_b32 s41, 49160
    buffer_load_dwordx2 v[138:139], v129, s[12:15], s41 offen sc1
    s_mov_b32 s41, 53256
    buffer_load_dwordx2 v[140:141], v129, s[12:15], s41 offen sc1
    s_mov_b32 s41, 57352
    buffer_load_dwordx2 v[142:143], v129, s[12:15], s41 offen sc1
    s_mov_b32 s41, 61448
    buffer_load_dwordx2 v[144:145], v129, s[12:15], s41 offen sc1
    s_waitcnt vmcnt(0)
    v_cmp_ne_u32 vcc, s36, v131
    v_cmp_ne_u32 s[56:57], s36, v133
    s_nop 0
    s_or_b64 vcc, vcc, s[56:57]
    v_cmp_ne_u32 s[56:57], s36, v135
    s_nop 0
    s_or_b64 vcc, vcc, s[56:57]
    v_cmp_ne_u32 s[56:57], s36, v137
    s_nop 0
    s_or_b64 vcc, vcc, s[56:57]
    v_cmp_ne_u32 s[56:57], s36, v139
    s_nop 0
    s_or_b64 vcc, vcc, s[56:57]
    v_cmp_ne_u32 s[56:57], s36, v141
    s_nop 0
    s_or_b64 vcc, vcc, s[56:57]
    v_cmp_ne_u32 s[56:57], s36, v143
    s_nop 0
    s_or_b64 vcc, vcc, s[56:57]
    v_cmp_ne_u32 s[56:57], s36, v145
    s_nop 0
    s_or_b64 vcc, vcc, s[56:57]
    s_cbranch_vccnz RETRY_8
OK_10:
    v_ashrrev_i32 v131, 31, v130
    v_or_b32 v131, 0x80000000, v131
    v_xor_b32 v130, v130, v131
    v_and_b32 v130, 0xfffff800, v130
    v_sub_u32 v131, 2047, v128
    v_or_b32 v130, v130, v131
    v_ashrrev_i32 v133, 31, v132
    v_or_b32 v133, 0x80000000, v133
    v_xor_b32 v132, v132, v133
    v_and_b32 v132, 0xfffff800, v132
    v_sub_u32 v133, 1791, v128
    v_or_b32 v132, v132, v133
    v_max_u32 v148, v130, v132
    v_min_u32 v149, v130, v132
    v_ashrrev_i32 v135, 31, v134
    v_or_b32 v135, 0x80000000, v135
    v_xor_b32 v134, v134, v135
    v_and_b32 v134, 0xfffff800, v134
    v_sub_u32 v135, 1535, v128
    v_or_b32 v134, v134, v135
    v_med3_u32 v149, v148, v149, v134
    v_max_u32 v148, v148, v134
    v_ashrrev_i32 v137, 31, v136
    v_or_b32 v137, 0x80000000, v137
    v_xor_b32 v136, v136, v137
    v_and_b32 v136, 0xfffff800, v136
    v_sub_u32 v137, 1279, v128
    v_or_b32 v136, v136, v137
    v_med3_u32 v149, v148, v149, v136
    v_max_u32 v148, v148, v136
    v_ashrrev_i32 v139, 31, v138
    v_or_b32 v139, 0x80000000, v139
    v_xor_b32 v138, v138, v139
    v_and_b32 v138, 0xfffff800, v138
    v_sub_u32 v139, 1023, v128
    v_or_b32 v138, v138, v139
    v_med3_u32 v149, v148, v149, v138
    v_max_u32 v148, v148, v138
    v_ashrrev_i32 v141, 31, v140
    v_or_b32 v141, 0x80000000, v141
    v_xor_b32 v140, v140, v141
    v_and_b32 v140, 0xfffff800, v140
    v_sub_u32 v141, 767, v128
    v_or_b32 v140, v140, v141
    v_med3_u32 v149, v148, v149, v140
    v_max_u32 v148, v148, v140
    v_ashrrev_i32 v143, 31, v142
    v_or_b32 v143, 0x80000000, v143
    v_xor_b32 v142, v142, v143
    v_and_b32 v142, 0xfffff800, v142
    v_sub_u32 v143, 511, v128
    v_or_b32 v142, v142, v143
    v_med3_u32 v149, v148, v149, v142
    v_max_u32 v148, v148, v142
    v_ashrrev_i32 v145, 31, v144
    v_or_b32 v145, 0x80000000, v145
    v_xor_b32 v144, v144, v145
    v_and_b32 v144, 0xfffff800, v144
    v_sub_u32 v145, 255, v128
    v_or_b32 v144, v144, v145
    v_med3_u32 v149, v148, v149, v144
    v_max_u32 v148, v148, v144
    v_mov_b32 v150, v148
    s_nop 1
    v_max_u32_dpp v150, v150, v150 row_shr:1 row_mask:0xf bank_mask:0xf
    s_nop 1
    v_max_u32_dpp v150, v150, v150 row_shr:2 row_mask:0xf bank_mask:0xf
    s_nop 1
    v_max_u32_dpp v150, v150, v150 row_shr:4 row_mask:0xf bank_mask:0xf
    s_nop 1
    v_max_u32_dpp v150, v150, v150 row_shr:8 row_mask:0xf bank_mask:0xf
    s_nop 1
    v_max_u32_dpp v150, v150, v150 row_bcast:15 row_mask:0xa bank_mask:0xf
    s_nop 1
    v_max_u32_dpp v150, v150, v150 row_bcast:31 row_mask:0xc bank_mask:0xf
    s_nop 0
    v_readlane_b32 s42, v150, 63
    s_nop 1
    v_cmp_eq_u32 vcc, s42, v148
    s_nop 1
    v_cndmask_b32 v150, v148, v149, vcc
    s_nop 1
    v_max_u32_dpp v150, v150, v150 row_shr:1 row_mask:0xf bank_mask:0xf
    s_nop 1
    v_max_u32_dpp v150, v150, v150 row_shr:2 row_mask:0xf bank_mask:0xf
    s_nop 1
    v_max_u32_dpp v150, v150, v150 row_shr:4 row_mask:0xf bank_mask:0xf
    s_nop 1
    v_max_u32_dpp v150, v150, v150 row_shr:8 row_mask:0xf bank_mask:0xf
    s_nop 1
    v_max_u32_dpp v150, v150, v150 row_bcast:15 row_mask:0xa bank_mask:0xf
    s_nop 1
    v_max_u32_dpp v150, v150, v150 row_bcast:31 row_mask:0xc bank_mask:0xf
    s_nop 0
    v_readlane_b32 s43, v150, 63
    v_mov_b32 v130, s42
    s_nop 0
    v_mov_b32 v131, s43
    s_lshl_b32 s41, s40, 3
    s_add_u32 s41, s41, 157952
    v_mov_b32 v132, s41
    ds_write_b64 v132, v[130:131]
    s_branch BACK_7
RETRY_8:
    s_mov_b32 s58, 200000
RETRYL_9:
    s_mov_b32 s41, 32776
    buffer_load_dwordx2 v[130:131], v129, s[12:15], s41 offen sc1
    s_mov_b32 s41, 36872
    buffer_load_dwordx2 v[132:133], v129, s[12:15], s41 offen sc1
    s_mov_b32 s41, 40968
    buffer_load_dwordx2 v[134:135], v129, s[12:15], s41 offen sc1
    s_mov_b32 s41, 45064
    buffer_load_dwordx2 v[136:137], v129, s[12:15], s41 offen sc1
    s_mov_b32 s41, 49160
    buffer_load_dwordx2 v[138:139], v129, s[12:15], s41 offen sc1
    s_mov_b32 s41, 53256
    buffer_load_dwordx2 v[140:141], v129, s[12:15], s41 offen sc1
    s_mov_b32 s41, 57352
    buffer_load_dwordx2 v[142:143], v129, s[12:15], s41 offen sc1
    s_mov_b32 s41, 61448
    buffer_load_dwordx2 v[144:145], v129, s[12:15], s41 offen sc1
    s_sub_u32 s58, s58, 1
    s_cbranch_scc1 OK_10x
    s_waitcnt vmcnt(0)
    v_cmp_ne_u32 vcc, s36, v131
    v_cmp_ne_u32 s[56:57], s36, v133
    s_nop 0
    s_or_b64 vcc, vcc, s[56:57]
    v_cmp_ne_u32 s[56:57], s36, v135
    s_nop 0
    s_or_b64 vcc, vcc, s[56:57]
    v_cmp_ne_u32 s[56:57], s36, v137
    s_nop 0
    s_or_b64 vcc, vcc, s[56:57]
    v_cmp_ne_u32 s[56:57], s36, v139
    s_nop 0
    s_or_b64 vcc, vcc, s[56:57]
    v_cmp_ne_u32 s[56:57], s36, v141
    s_nop 0
    s_or_b64 vcc, vcc, s[56:57]
    v_cmp_ne_u32 s[56:57], s36, v143
    s_nop 0
    s_or_b64 vcc, vcc, s[56:57]
    v_cmp_ne_u32 s[56:57], s36, v145
    s_nop 0
    s_or_b64 vcc, vcc, s[56:57]
    s_cbranch_vccnz RETRYL_9
OK_10x:
    s_waitcnt vmcnt(0)
    s_branch OK_10
RETRY_11:
    s_mov_b32 s58, 200000
RETRYL_12:
    buffer_load_dwordx4 v[64:67], v126, s[12:15], s71 offen sc1
    s_sub_u32 s58, s58, 1
    s_cbranch_scc1 OK_13x
    s_waitcnt vmcnt(0)
    v_cmp_ne_u32 vcc, s36, v67
    s_cbranch_vccnz RETRYL_12
OK_13x:
    s_waitcnt vmcnt(0)
    s_branch OK_13
RETRY_14:
    s_mov_b32 s58, 200000
RETRYL_15:
    buffer_load_dwordx4 v[64:67], v126, s[12:15], s71 offen sc1
    s_sub_u32 s58, s58, 1
    s_cbranch_scc1 OK_16x
    s_waitcnt vmcnt(0)
    v_cmp_ne_u32 vcc, s36, v67
    s_cbranch_vccnz RETRYL_15
OK_16x:
    s_waitcnt vmcnt(0)
    s_branch OK_16
RETRY_17:
    s_mov_b32 s58, 200000
RETRYL_18:
    buffer_load_dwordx4 v[68:71], v126, s[12:15], s3 offen sc1
    s_sub_u32 s58, s58, 1
    s_cbranch_scc1 OK_19x
    s_waitcnt vmcnt(0)
    v_cmp_ne_u32 vcc, s36, v71
    s_cbranch_vccnz RETRYL_18
OK_19x:
    s_waitcnt vmcnt(0)
    s_branch OK_19
PK_20:
    s_call_b64 s[56:57], L_POLL0
    s_branch PKD_21
PK_22:
    s_call_b64 s[56:57], L_POLL0
    s_branch PKD_23
PK_24:
    s_call_b64 s[56:57], L_POLL0
    s_branch PKD_25
PK_26:
    s_call_b64 s[56:57], L_POLL0
    s_branch PKD_27
PK_28:
    s_call_b64 s[56:57], L_POLL1
    s_branch PKD_29
PK_30:
    s_call_b64 s[56:57], L_POLL1
    s_branch PKD_31
PK_32:
    s_call_b64 s[56:57], L_POLL1
    s_branch PKD_33
PK_34:
    s_call_b64 s[56:57], L_POLL1
    s_branch PKD_35
RETRY_36:
    s_mov_b32 s58, 200000
RETRYL_37:
    s_sleep 1
    ds_read_b128 v[228:231], v232 offset:3072
    ds_read_b128 v[216:219], v232 offset:0
    ds_read_b128 v[220:223], v232 offset:1024
    ds_read_b128 v[224:227], v232 offset:2048
    s_sub_u32 s58, s58, 1
    s_cbranch_scc1 OK_38x
    s_waitcnt lgkmcnt(0)
    v_cmp_gt_f32 vcc, 0.5, v231
    s_nop 0
    s_andn2_b64 vcc, vcc, s[54:55]
    s_cbranch_vccnz RETRYL_37
OK_38x:
    s_waitcnt lgkmcnt(0)
    s_branch OK_38
RETRY_39:
    s_mov_b32 s58, 200000
RETRYL_40:
    s_sleep 1
    ds_read_b128 v[228:231], v232 offset:3072
    ds_read_b128 v[216:219], v232 offset:0
    ds_read_b128 v[220:223], v232 offset:1024
    ds_read_b128 v[224:227], v232 offset:2048
    s_sub_u32 s58, s58, 1
    s_cbranch_scc1 OK_41x
    s_waitcnt lgkmcnt(0)
    v_cmp_gt_f32 vcc, 0x3fc00000, v231
    s_nop 0
    s_andn2_b64 vcc, vcc, s[54:55]
    s_cbranch_vccnz RETRYL_40
OK_41x:
    s_waitcnt lgkmcnt(0)
    s_branch OK_41
RETRY_42:
    s_mov_b32 s58, 200000
RETRYL_43:
    s_sleep 1
    ds_read_b128 v[228:231], v232 offset:3072
    ds_read_b128 v[216:219], v232 offset:0
    ds_read_b128 v[220:223], v232 offset:1024
    ds_read_b128 v[224:227], v232 offset:2048
    s_sub_u32 s58, s58, 1
    s_cbranch_scc1 OK_44x
    s_waitcnt lgkmcnt(0)
    v_cmp_gt_f32 vcc, 0x40200000, v231
    s_nop 0
    s_andn2_b64 vcc, vcc, s[54:55]
    s_cbranch_vccnz RETRYL_43
OK_44x:
    s_waitcnt lgkmcnt(0)
    s_branch OK_44
RETRY_45:
    s_mov_b32 s58, 200000
RETRYL_46:
    s_add_u32 s42, s49, 0
    buffer_load_dwordx3 v[40:42], v247, s[12:15], s42 offen sc1
    s_add_u32 s42, s49, 28672
    buffer_load_dwordx3 v[44:46], v247, s[12:15], s42 offen sc1
    s_add_u32 s42, s49, 57344
    buffer_load_dwordx3 v[48:50], v247, s[12:15], s42 offen sc1
    s_add_u32 s42, s49, 86016
    buffer_load_dwordx3 v[52:54], v247, s[12:15], s42 offen sc1
    s_sub_u32 s58, s58, 1
    s_cbranch_scc1 OK_47x
    s_waitcnt vmcnt(0)
    v_xor_b32 v43, s36, v42
    v_xor_b32 v47, s36, v46
    v_xor_b32 v51, s36, v50
    v_or3_b32 v43, v43, v47, v51
    v_xor_b32 v47, s36, v54
    v_or_b32 v43, v43, v47
    v_cmp_ne_u32 vcc, 0, v43
    s_cbranch_vccnz RETRYL_46
OK_47x:
    s_waitcnt vmcnt(0)
    s_branch OK_47
SIDE_48:
    v_mov_b32 v76, 157776
    ds_read_b128 v[72:75], v76
    s_waitcnt lgkmcnt(0)
    v_and_b32 v72, v72, v73
    v_and_b32 v74, v74, v75
    v_and_b32 v72, v72, v74
    v_cmp_eq_u32 vcc, 0, v72
    s_cbranch_vccnz RETRY_50
OK_52:
    v_mov_b32 v76, 157840
    ds_read_b128 v[72:75], v76
    s_waitcnt lgkmcnt(0)
    v_and_b32 v72, v72, v73
    v_and_b32 v74, v74, v75
    v_and_b32 v72, v72, v74
    v_cmp_eq_u32 vcc, 0, v72
    s_cbranch_vccnz RETRY_53
OK_55:
    v_lshrrev_b32 v46, 2, v0
    v_xor_b32 v47, v46, v0
    v_and_b32 v47, 4, v47
    v_cmp_eq_u32 vcc, 0, v47
    v_and_b32 v44, 1, v0
    v_and_b32 v45, 3, v46
    v_cndmask_b32 v44, 2, v44, vcc
    v_mul_u32_u24 v44, 224, v44
    v_lshl_add_u32 v44, v5, 4, v44
    v_add_u32 v44, 159552, v44
    v_lshl_add_u32 v45, v5, 3, v45
    v_lshlrev_b32 v45, 3, v45
    v_and_b32 v46, 4, v46
    v_and_or_b32 v46, v0, 3, v46
    v_add_lshl_u32 v45, v45, v46, 3
    v_add_u32 v45, 149504, v45
    ds_read_b128 v[46:49], v44 offset:0
    ds_read_b64_tr_b16 v[50:51], v45 offset:0
    ds_read_b64_tr_b16 v[52:53], v45 offset:256
    ds_read_b128 v[54:57], v44 offset:32
    ds_read_b64_tr_b16 v[58:59], v45 offset:1024
    ds_read_b64_tr_b16 v[60:61], v45 offset:1280
    ds_read_b128 v[62:65], v44 offset:64
    ds_read_b64_tr_b16 v[66:67], v45 offset:2048
    ds_read_b64_tr_b16 v[68:69], v45 offset:2304
    s_waitcnt lgkmcnt(6)
    v_mfma_f32_16x16x32_bf16 v[40:43], v[46:49], v[50:53], 0
    ds_read_b128 v[46:49], v44 offset:96
    ds_read_b64_tr_b16 v[50:51], v45 offset:3072
    ds_read_b64_tr_b16 v[52:53], v45 offset:3328
    s_waitcnt lgkmcnt(6)
    v_mfma_f32_16x16x32_bf16 v[40:43], v[54:57], v[58:61], v[40:43]
    ds_read_b128 v[54:57], v44 offset:128
    ds_read_b64_tr_b16 v[58:59], v45 offset:4096
    ds_read_b64_tr_b16 v[60:61], v45 offset:4352
    s_waitcnt lgkmcnt(6)
    v_mfma_f32_16x16x32_bf16 v[40:43], v[62:65], v[66:69], v[40:43]
    ds_read_b128 v[62:65], v44 offset:160
    ds_read_b64_tr_b16 v[66:67], v45 offset:5120
    ds_read_b64_tr_b16 v[68:69], v45 offset:5376
    s_waitcnt lgkmcnt(6)
    v_mfma_f32_16x16x32_bf16 v[40:43], v[46:49], v[50:53], v[40:43]
    ds_read_b128 v[46:49], v44 offset:192
    ds_read_b64_tr_b16 v[50:51], v45 offset:6144
    ds_read_b64_tr_b16 v[52:53], v45 offset:6400
    s_waitcnt lgkmcnt(6)
    v_mfma_f32_16x16x32_bf16 v[40:43], v[54:57], v[58:61], v[40:43]
    s_waitcnt lgkmcnt(3)
    v_mfma_f32_16x16x32_bf16 v[40:43], v[62:65], v[66:69], v[40:43]
    s_waitcnt lgkmcnt(0)
    v_mfma_f32_16x16x32_bf16 v[40:43], v[46:49], v[50:53], v[40:43]
    s_lshl_b32 s41, s62, 9
    s_and_b32 s42, s2, 8
    s_lshl_b32 s42, s42, 5
    s_add_u32 s41, s41, s42
    s_add_u32 s41, s41, 720896
    s_add_u32 s42, s41, 57344
    s_nop 1
    v_mov_b32 v42, v41
    v_mov_b32 v41, s36
    v_mov_b32 v43, s36
    s_mov_b64 exec, s[54:55]
    buffer_store_dwordx2 v[40:41], v3, s[12:15], s41 offen sc1
    buffer_store_dwordx2 v[42:43], v3, s[12:15], s42 offen sc1
    s_mov_b64 exec, -1
    s_branch BACK_49
RETRY_50:
    s_mov_b32 s58, 200000
RETRYL_51:
    s_sleep 2
    ds_read_b128 v[72:75], v76
    s_sub_u32 s58, s58, 1
    s_cbranch_scc1 OK_52x
    s_waitcnt lgkmcnt(0)
    v_and_b32 v72, v72, v73
    v_and_b32 v74, v74, v75
    v_and_b32 v72, v72, v74
    v_cmp_eq_u32 vcc, 0, v72
    s_cbranch_vccnz RETRYL_51
OK_52x:
    s_waitcnt lgkmcnt(0)
    s_branch OK_52
RETRY_53:
    s_mov_b32 s58, 200000
RETRYL_54:
    s_sleep 2
    ds_read_b128 v[72:75], v76
    s_sub_u32 s58, s58, 1
    s_cbranch_scc1 OK_55x
    s_waitcnt lgkmcnt(0)
    v_and_b32 v72, v72, v73
    v_and_b32 v74, v74, v75
    v_and_b32 v72, v72, v74
    v_cmp_eq_u32 vcc, 0, v72
    s_cbranch_vccnz RETRYL_54
OK_55x:
    s_waitcnt lgkmcnt(0)
    s_branch OK_55
RETRY_56:
    s_mov_b32 s58, 200000
RETRYL_57:
    buffer_load_dwordx4 v[64:67], v126, s[12:15], s71 offen sc1
    s_sub_u32 s58, s58, 1
    s_cbranch_scc1 OK_58x
    s_waitcnt vmcnt(0)
    v_cmp_ne_u32 vcc, s36, v67
    s_cbranch_vccnz RETRYL_57
OK_58x:
    s_waitcnt vmcnt(0)
    s_branch OK_58
SIDE_59:
    s_waitcnt vmcnt(0)
    v_lshlrev_b32 v146, 16, v128
    v_and_b32 v147, 0xffff0000, v128
    v_sub_f32 v146, v146, v136
    v_sub_f32 v147, v147, v136
    v_cvt_pk_bf16_f32 v128, v146, v147
    v_lshlrev_b32 v146, 16, v128
    v_and_b32 v147, 0xffff0000, v128
    v_mul_f32 v146, v146, v137
    v_mul_f32 v147, v147, v137
    v_cvt_pk_bf16_f32 v128, v146, v147
    v_lshlrev_b32 v146, 16, v129
    v_and_b32 v147, 0xffff0000, v129
    v_sub_f32 v146, v146, v136
    v_sub_f32 v147, v147, v136
    v_cvt_pk_bf16_f32 v129, v146, v147
    v_lshlrev_b32 v146, 16, v129
    v_and_b32 v147, 0xffff0000, v129
    v_mul_f32 v146, v146, v137
    v_mul_f32 v147, v147, v137
    v_cvt_pk_bf16_f32 v129, v146, v147
    v_lshlrev_b32 v146, 16, v130
    v_and_b32 v147, 0xffff0000, v130
    v_sub_f32 v146, v146, v136
    v_sub_f32 v147, v147, v136
    v_cvt_pk_bf16_f32 v130, v146, v147
    v_lshlrev_b32 v146, 16, v130
    v_and_b32 v147, 0xffff0000, v130
    v_mul_f32 v146, v146, v137
    v_mul_f32 v147, v147, v137
    v_cvt_pk_bf16_f32 v130, v146, v147
    v_lshlrev_b32 v146, 16, v131
    v_and_b32 v147, 0xffff0000, v131
    v_sub_f32 v146, v146, v136
    v_sub_f32 v147, v147, v136
    v_cvt_pk_bf16_f32 v131, v146, v147
    v_lshlrev_b32 v146, 16, v131
    v_and_b32 v147, 0xffff0000, v131
    v_mul_f32 v146, v146, v137
    v_mul_f32 v147, v147, v137
    v_cvt_pk_bf16_f32 v131, v146, v147
    v_lshlrev_b32 v146, 16, v132
    v_and_b32 v147, 0xffff0000, v132
    v_sub_f32 v146, v146, v140
    v_sub_f32 v147, v147, v140
    v_cvt_pk_bf16_f32 v132, v146, v147
    v_lshlrev_b32 v146, 16, v132
    v_and_b32 v147, 0xffff0000, v132
    v_mul_f32 v146, v146, v141
    v_mul_f32 v147, v147, v141
    v_cvt_pk_bf16_f32 v132, v146, v147
    v_lshlrev_b32 v146, 16, v133
    v_and_b32 v147, 0xffff0000, v133
    v_sub_f32 v146, v146, v140
    v_sub_f32 v147, v147, v140
    v_cvt_pk_bf16_f32 v133, v146, v147
    v_lshlrev_b32 v146, 16, v133
    v_and_b32 v147, 0xffff0000, v133
    v_mul_f32 v146, v146, v141
    v_mul_f32 v147, v147, v141
    v_cvt_pk_bf16_f32 v133, v146, v147
    v_lshlrev_b32 v146, 16, v134
    v_and_b32 v147, 0xffff0000, v134
    v_sub_f32 v146, v146, v140
    v_sub_f32 v147, v147, v140
    v_cvt_pk_bf16_f32 v134, v146, v147
    v_lshlrev_b32 v146, 16, v134
    v_and_b32 v147, 0xffff0000, v134
    v_mul_f32 v146, v146, v141
    v_mul_f32 v147, v147, v141
    v_cvt_pk_bf16_f32 v134, v146, v147
    v_lshlrev_b32 v146, 16, v135
    v_and_b32 v147, 0xffff0000, v135
    v_sub_f32 v146, v146, v140
    v_sub_f32 v147, v147, v140
    v_cvt_pk_bf16_f32 v135, v146, v147
    v_lshlrev_b32 v146, 16, v135
    v_and_b32 v147, 0xffff0000, v135
    v_mul_f32 v146, v146, v141
    v_mul_f32 v147, v147, v141
    v_cvt_pk_bf16_f32 v135, v146, v147
    v_min_u32 v144, 55, v0
    v_lshlrev_b32 v144, 4, v144
    s_mov_b32 s41, 4096
    buffer_store_dwordx4 v[128:131], v144, s[12:15], s41 offen sc1
    buffer_store_dwordx4 v[132:135], v144, s[12:15], s41 offen offset:896 sc1
    v_cvt_pk_bf16_f32 v146, v138, v142
    v_lshlrev_b32 v147, 16, v146
    v_and_b32 v148, 0xffff0000, v146
    v_mul_f32 v147, 0xbfb8aa3b, v147
    v_exp_f32 v147, v147
    s_nop 0
    v_add_f32 v147, 1.0, v147
    v_rcp_f32 v147, v147
    v_mul_f32 v148, 0xbfb8aa3b, v148
    v_exp_f32 v148, v148
    s_nop 0
    v_add_f32 v148, 1.0, v148
    v_rcp_f32 v148, v148
    s_nop 0
    v_cvt_pk_bf16_f32 v18, v147, v148
    v_mov_b32 v16, s49
    v_mov_b32 v17, s50
    v_mov_b32 v19, s36
    v_mov_b32 v145, 256
    s_mov_b64 exec, 1
    s_waitcnt vmcnt(0)
    buffer_store_dwordx4 v[16:19], v145, s[12:15], 0 offen sc1
    s_mov_b64 exec, -1
    s_branch BACK_60
PK_64:
    s_call_b64 s[56:57], L_POLL0
    s_branch PKD_65
PK_66:
    s_call_b64 s[56:57], L_POLL0
    s_branch PKD_67
PEND_61:
    s_add_u32 s32, s32, 1
    s_cmp_lt_u32 s32, 2
    s_cbranch_scc0 PENDX_68
    s_load_dwordx4 s[80:83], s[76:77], 0 glc
    s_load_dwordx4 s[84:87], s[76:77], 32768 glc
    s_load_dwordx4 s[88:91], s[76:77], 65536 glc
    s_load_dwordx4 s[92:95], s[76:77], 98304 glc
    s_branch LOOK_62
PENDX_68:
    s_waitcnt vmcnt(0)
    s_branch PENDD_63
SIDE_69:
    s_andn2_b32 s41, s70, s33
    s_cbranch_scc0 PK_71
PKD_72:
    s_ff1_i32_b32 s41, s41
    s_bitset0_b32 s70, s41
    s_lshl_b32 s42, s41, 15
    s_mul_i32 s41, s41, 458752
    s_add_u32 s42, s42, s98
    s_add_u32 s41, s41, s59
    buffer_load_dwordx4 v[152:155], v6, s[12:15], s41 offen offset:0 sc1
    buffer_load_dwordx4 v[156:159], v6, s[12:15], s41 offen offset:1024 sc1
    s_mov_b64 exec, s[52:53]
    buffer_load_dwordx4 v[160:163], v6, s[12:15], s42 offen offset:0 sc1
    buffer_load_dwordx4 v[164:167], v6, s[12:15], s42 offen offset:1024 sc1
    s_mov_b64 exec, -1
    s_andn2_b32 s41, s70, s33
    s_cbranch_scc0 PK_73
PKD_74:
    s_ff1_i32_b32 s41, s41
    s_bitset0_b32 s70, s41
    s_lshl_b32 s42, s41, 15
    s_mul_i32 s41, s41, 458752
    s_add_u32 s42, s42, s98
    s_add_u32 s41, s41, s59
    buffer_load_dwordx4 v[168:171], v6, s[12:15], s41 offen offset:0 sc1
    buffer_load_dwordx4 v[172:175], v6, s[12:15], s41 offen offset:1024 sc1
    s_mov_b64 exec, s[52:53]
    buffer_load_dwordx4 v[176:179], v6, s[12:15], s42 offen offset:0 sc1
    buffer_load_dwordx4 v[180:183], v6, s[12:15], s42 offen offset:1024 sc1
    s_mov_b64 exec, -1
    v_mov_b32 v216, s36
    s_mov_b64 exec, 7
    buffer_store_dword v216, v251, s[12:15], s75 offen sc1
    s_mov_b64 exec, -1
    s_branch BACK_70
PK_71:
    s_call_b64 s[56:57], L_POLL0
    s_branch PKD_72
PK_73:
    s_call_b64 s[56:57], L_POLL0
    s_branch PKD_74
SIDE_75:
    s_load_dwordx4 s[80:83], s[76:77], 0 glc
    s_load_dwordx4 s[84:87], s[76:77], 32768 glc
    s_load_dwordx4 s[88:91], s[76:77], 65536 glc
    s_load_dwordx4 s[92:95], s[76:77], 98304 glc
    s_branch BACK_76
PK_77:
    s_call_b64 s[56:57], L_POLL0
    s_branch PKD_78
PK_79:
    s_call_b64 s[56:57], L_POLL0
    s_branch PKD_80
PK_81:
    s_call_b64 s[56:57], L_POLL1
    s_branch PKD_82
PK_83:
    s_call_b64 s[56:57], L_POLL1
    s_branch PKD_84
PK_85:
    s_call_b64 s[56:57], L_POLL1
    s_branch PKD_86
RETRY_87:
    s_mov_b32 s58, 200000
RETRYL_88:
    s_sleep 4
    buffer_load_dword v216, v217, s[12:15], 0 offen sc1
    s_sub_u32 s58, s58, 1
    s_cbranch_scc1 OK_89x
    s_waitcnt vmcnt(0)
    v_cmp_ne_u32 vcc, s36, v216
    s_cbranch_vccnz RETRYL_88
OK_89x:
    s_waitcnt vmcnt(0)
    s_branch OK_89
PK_90:
    s_call_b64 s[56:57], L_POLL1
    s_branch PKD_91
RETRY_92:
    s_mov_b32 s58, 200000
RETRYL_93:
    s_sleep 2
    ds_read_b128 v[222:225], v226
    s_sub_u32 s58, s58, 1
    s_cbranch_scc1 OK_94x
    s_waitcnt lgkmcnt(0)
    v_and_b32 v222, v222, v223
    v_and_b32 v224, v224, v225
    v_and_b32 v222, v222, v224
    v_cmp_eq_u32 vcc, 0, v222
    s_cbranch_vccnz RETRYL_93
OK_94x:
    s_waitcnt lgkmcnt(0)
    s_branch OK_94
SIDE_95:
    s_lshl_b32 s41, s62, 10
    s_and_b32 s42, s2, 8
    s_lshl_b32 s42, s42, 6
    s_add_u32 s41, s41, s42
    s_and_b32 s42, s40, 1
    s_lshl_b32 s42, s42, 8
    s_add_u32 s41, s41, s42
    s_add_u32 s41, s41, 589824
    v_mov_b32 v218, s36
    s_mov_b64 exec, 0xffff
    buffer_store_dwordx4 v[216:219], v6, s[12:15], s41 offen sc1
    s_mov_b64 exec, -1
    s_branch BACK_96
RETRY_97:
    s_mov_b32 s58, 200000
RETRYL_98:
    s_sleep 1
    ds_read_b128 v[228:231], v232 offset:3072
    ds_read_b128 v[216:219], v232 offset:0
    ds_read_b128 v[220:223], v232 offset:1024
    ds_read_b128 v[224:227], v232 offset:2048
    s_sub_u32 s58, s58, 1
    s_cbranch_scc1 OK_99x
    s_waitcnt lgkmcnt(0)
    v_cmp_gt_f32 vcc, 0.5, v231
    s_nop 0
    s_andn2_b64 vcc, vcc, s[54:55]
    s_cbranch_vccnz RETRYL_98
OK_99x:
    s_waitcnt lgkmcnt(0)
    s_branch OK_99
RETRY_100:
    s_mov_b32 s58, 200000
RETRYL_101:
    s_sleep 1
    ds_read_b128 v[228:231], v232 offset:3072
    ds_read_b128 v[216:219], v232 offset:0
    ds_read_b128 v[220:223], v232 offset:1024
    ds_read_b128 v[224:227], v232 offset:2048
    s_sub_u32 s58, s58, 1
    s_cbranch_scc1 OK_102x
    s_waitcnt lgkmcnt(0)
    v_cmp_gt_f32 vcc, 0x3fc00000, v231
    s_nop 0
    s_andn2_b64 vcc, vcc, s[54:55]
    s_cbranch_vccnz RETRYL_101
OK_102x:
    s_waitcnt lgkmcnt(0)
    s_branch OK_102
RETRY_103:
    s_mov_b32 s58, 200000
RETRYL_104:
    s_sleep 1
    ds_read_b128 v[228:231], v232 offset:3072
    ds_read_b128 v[216:219], v232 offset:0
    ds_read_b128 v[220:223], v232 offset:1024
    ds_read_b128 v[224:227], v232 offset:2048
    s_sub_u32 s58, s58, 1
    s_cbranch_scc1 OK_105x
    s_waitcnt lgkmcnt(0)
    v_cmp_gt_f32 vcc, 0x40200000, v231
    s_nop 0
    s_andn2_b64 vcc, vcc, s[54:55]
    s_cbranch_vccnz RETRYL_104
OK_105x:
    s_waitcnt lgkmcnt(0)
    s_branch OK_105
RETRY_106:
    s_mov_b32 s58, 200000
RETRYL_107:
    s_sleep 1
    ds_read_b128 v[52:55], v233 offset:3072
    ds_read_b128 v[40:43], v233 offset:0
    ds_read_b128 v[44:47], v233 offset:1024
    ds_read_b128 v[48:51], v233 offset:2048
    s_sub_u32 s58, s58, 1
    s_cbranch_scc1 OK_108x
    s_waitcnt lgkmcnt(0)
    v_cmp_gt_f32 vcc, 0x40600000, v55
    s_nop 0
    s_andn2_b64 vcc, vcc, s[54:55]
    s_cbranch_vccnz RETRYL_107
OK_108x:
    s_waitcnt lgkmcnt(0)
    s_branch OK_108
RETRY_109:
    s_mov_b32 s58, 200000
RETRYL_110:
    s_sleep 2
    ds_read_b32 v8, v9
    s_sub_u32 s58, s58, 1
    s_cbranch_scc1 OK_111x
    s_waitcnt lgkmcnt(0)
    v_cmp_eq_u32 vcc, 0, v8
    s_cbranch_vccnz RETRYL_110
OK_111x:
    s_waitcnt lgkmcnt(0)
    s_branch OK_111
RETRY_112:
    s_mov_b32 s58, 200000
RETRYL_113:
    s_load_dwordx4 s[68:71], s[12:13], 256 glc
    s_sub_u32 s58, s58, 1
    s_cbranch_scc1 OK_114x
    s_waitcnt lgkmcnt(0)
    s_cmp_lg_u32 s71, s36
    s_cselect_b64 vcc, -1, 0
    s_cbranch_vccnz RETRYL_113
OK_114x:
    s_waitcnt lgkmcnt(0)
    s_branch OK_114
SIDE_115:
    s_load_dword s64, s[76:77], 0 glc
    s_load_dword s65, s[76:77], 128 glc
    s_load_dword s66, s[76:77], 256 glc
    s_load_dword s67, s[76:77], 384 glc
    s_mov_b32 m0, s51
    v_mov_b32 v124, 157824
    ds_read_b128 v[120:123], v124
    s_waitcnt lgkmcnt(0)
    v_and_b32 v120, v120, v121
    v_and_b32 v122, v122, v123
    v_and_b32 v120, v120, v122
    v_cmp_eq_u32 vcc, 0, v120
    s_cbranch_vccnz RETRY_117
OK_119:
    s_waitcnt lgkmcnt(0)
    s_xor_b64 vcc, s[64:65], s[36:37]
    s_xor_b64 s[66:67], s[66:67], s[36:37]
    s_or_b64 vcc, vcc, s[66:67]
    s_cbranch_vccnz RETRY_120
OK_122:
    buffer_load_dwordx4 v6, s[12:15], s59 offen offset:0 sc1 lds
    buffer_load_dwordx4 v6, s[12:15], s59 offen offset:1024 sc1 lds
    buffer_load_dwordx4 v6, s[12:15], s59 offen offset:2048 sc1 lds
    buffer_load_dwordx4 v6, s[12:15], s59 offen offset:3072 sc1 lds
    s_add_u32 m0, s51, 4096
    s_add_u32 s59, s59, 4096
    buffer_load_dwordx4 v6, s[12:15], s59 offen offset:0 sc1 lds
    buffer_load_dwordx4 v6, s[12:15], s59 offen offset:1024 sc1 lds
    buffer_load_dwordx4 v6, s[12:15], s59 offen offset:2048 sc1 lds
    s_waitcnt vmcnt(7)
    s_branch L_HAVEX
    s_branch BACK_116
RETRY_117:
    s_mov_b32 s58, 200000
RETRYL_118:
    s_sleep 2
    ds_read_b128 v[120:123], v124
    s_sub_u32 s58, s58, 1
    s_cbranch_scc1 OK_119x
    s_waitcnt lgkmcnt(0)
    v_and_b32 v120, v120, v121
    v_and_b32 v122, v122, v123
    v_and_b32 v120, v120, v122
    v_cmp_eq_u32 vcc, 0, v120
    s_cbranch_vccnz RETRYL_118
OK_119x:
    s_waitcnt lgkmcnt(0)
    s_branch OK_119
RETRY_120:
    s_mov_b32 s58, 200000
RETRYL_121:
    s_load_dword s64, s[76:77], 0 glc
    s_load_dword s65, s[76:77], 128 glc
    s_load_dword s66, s[76:77], 256 glc
    s_load_dword s67, s[76:77], 384 glc
    s_sub_u32 s58, s58, 1
    s_cbranch_scc1 OK_122x
    s_waitcnt lgkmcnt(0)
    s_xor_b64 vcc, s[64:65], s[36:37]
    s_xor_b64 s[66:67], s[66:67], s[36:37]
    s_or_b64 vcc, vcc, s[66:67]
    s_cbranch_vccnz RETRYL_121
OK_122x:
    s_waitcnt lgkmcnt(0)
    s_branch OK_122
SIDE_123:
    s_lshl_b32 s41, s45, 5
    v_add_u32 v213, s41, v4
    v_min_u32 v213, 111, v213
    v_mul_u32_u24 v214, 3584, v5
    v_add_lshl_u32 v213, v213, v214, 3
    s_lshl_b32 s43, s40, 8
    s_add_u32 s43, s43, 160256
    v_lshl_add_u32 v214, v4, 2, s43
    s_cmp_eq_u64 s[52:53], 0
    s_cbranch_scc1 NT_125
    s_mul_i32 s41, s48, 896
    s_add_u32 s41, s41, 720896
    s_add_u32 s42, s41, 0
    buffer_load_dwordx2 v[120:121], v213, s[12:15], s42 offen sc1
    s_add_u32 s42, s41, 3584
    buffer_load_dwordx2 v[122:123], v213, s[12:15], s42 offen sc1
    s_add_u32 s42, s41, 7168
    buffer_load_dwordx2 v[124:125], v213, s[12:15], s42 offen sc1
    s_add_u32 s42, s41, 10752
    buffer_load_dwordx2 v[126:127], v213, s[12:15], s42 offen sc1
    s_add_u32 s42, s41, 14336
    buffer_load_dwordx2 v[128:129], v213, s[12:15], s42 offen sc1
    s_add_u32 s42, s41, 17920
    buffer_load_dwordx2 v[130:131], v213, s[12:15], s42 offen sc1
    s_add_u32 s42, s41, 21504
    buffer_load_dwordx2 v[132:133], v213, s[12:15], s42 offen sc1
    s_add_u32 s42, s41, 25088
    buffer_load_dwordx2 v[134:135], v213, s[12:15], s42 offen sc1
    s_waitcnt vmcnt(0)
    v_cmp_ne_u32 vcc, s36, v121
    v_cmp_ne_u32 s[56:57], s36, v123
    s_nop 0
    s_or_b64 vcc, vcc, s[56:57]
    v_cmp_ne_u32 s[56:57], s36, v125
    s_nop 0
    s_or_b64 vcc, vcc, s[56:57]
    v_cmp_ne_u32 s[56:57], s36, v127
    s_nop 0
    s_or_b64 vcc, vcc, s[56:57]
    v_cmp_ne_u32 s[56:57], s36, v129
    s_nop 0
    s_or_b64 vcc, vcc, s[56:57]
    v_cmp_ne_u32 s[56:57], s36, v131
    s_nop 0
    s_or_b64 vcc, vcc, s[56:57]
    v_cmp_ne_u32 s[56:57], s36, v133
    s_nop 0
    s_or_b64 vcc, vcc, s[56:57]
    v_cmp_ne_u32 s[56:57], s36, v135
    s_nop 0
    s_or_b64 vcc, vcc, s[56:57]
    s_cbranch_vccnz RETRY_126
OK_128:
    v_add_f32 v120, v120, v122
    v_add_f32 v124, v124, v126
    v_add_f32 v128, v128, v130
    v_add_f32 v132, v132, v134
    v_add_f32 v120, v120, v124
    v_add_f32 v128, v128, v132
    v_add_f32 v120, v120, v128
    v_mov_b32 v121, v120
    s_lshl_b32 s42, s70, 16
    s_nop 0
    v_permlane32_swap_b32 v120, v121
    v_add_f32 v120, v120, v121
    v_cvt_pk_bf16_f32 v120, v120, v120
    v_lshlrev_b32 v120, 16, v120
    v_mul_f32 v120, s42, v120
    v_cvt_pk_bf16_f32 v120, v120, v120
    v_lshlrev_b32 v120, 16, v120
    ds_write_b32 v214, v120 offset:0
NT_125:
    s_cmp_eq_u64 s[72:73], 0
    s_cbranch_scc1 NT_129
    s_mul_i32 s41, s48, 896
    s_add_u32 s41, s41, 778240
    s_add_u32 s42, s41, 0
    buffer_load_dwordx2 v[120:121], v213, s[12:15], s42 offen sc1
    s_add_u32 s42, s41, 3584
    buffer_load_dwordx2 v[122:123], v213, s[12:15], s42 offen sc1
    s_add_u32 s42, s41, 7168
    buffer_load_dwordx2 v[124:125], v213, s[12:15], s42 offen sc1
    s_add_u32 s42, s41, 10752
    buffer_load_dwordx2 v[126:127], v213, s[12:15], s42 offen sc1
    s_add_u32 s42, s41, 14336
    buffer_load_dwordx2 v[128:129], v213, s[12:15], s42 offen sc1
    s_add_u32 s42, s41, 17920
    buffer_load_dwordx2 v[130:131], v213, s[12:15], s42 offen sc1
    s_add_u32 s42, s41, 21504
    buffer_load_dwordx2 v[132:133], v213, s[12:15], s42 offen sc1
    s_add_u32 s42, s41, 25088
    buffer_load_dwordx2 v[134:135], v213, s[12:15], s42 offen sc1
    s_waitcnt vmcnt(0)
    v_cmp_ne_u32 vcc, s36, v121
    v_cmp_ne_u32 s[56:57], s36, v123
    s_nop 0
    s_or_b64 vcc, vcc, s[56:57]
    v_cmp_ne_u32 s[56:57], s36, v125
    s_nop 0
    s_or_b64 vcc, vcc, s[56:57]
    v_cmp_ne_u32 s[56:57], s36, v127
    s_nop 0
    s_or_b64 vcc, vcc, s[56:57]
    v_cmp_ne_u32 s[56:57], s36, v129
    s_nop 0
    s_or_b64 vcc, vcc, s[56:57]
    v_cmp_ne_u32 s[56:57], s36, v131
    s_nop 0
    s_or_b64 vcc, vcc, s[56:57]
    v_cmp_ne_u32 s[56:57], s36, v133
    s_nop 0
    s_or_b64 vcc, vcc, s[56:57]
    v_cmp_ne_u32 s[56:57], s36, v135
    s_nop 0
    s_or_b64 vcc, vcc, s[56:57]
    s_cbranch_vccnz RETRY_130
OK_132:
    v_add_f32 v120, v120, v122
    v_add_f32 v124, v124, v126
    v_add_f32 v128, v128, v130
    v_add_f32 v132, v132, v134
    v_add_f32 v120, v120, v124
    v_add_f32 v128, v128, v132
    v_add_f32 v120, v120, v128
    v_mov_b32 v121, v120
    s_and_b32 s42, s70, 0xffff0000
    s_nop 0
    v_permlane32_swap_b32 v120, v121
    v_add_f32 v120, v120, v121
    v_cvt_pk_bf16_f32 v120, v120, v120
    v_lshlrev_b32 v120, 16, v120
    v_mul_f32 v120, s42, v120
    v_cvt_pk_bf16_f32 v120, v120, v120
    v_lshlrev_b32 v120, 16, v120
    ds_write_b32 v214, v120 offset:128
NT_129:
    v_and_b32 v213, 3, v206
    v_lshl_add_u32 v213, v213, 5, s43
    v_add_u32 v214, 128, v213
    v_cndmask_b32 v213, v213, v214, s[72:73]
    ds_read_b128 v[216:219], v213
    ds_read_b128 v[220:223], v213 offset:16
    s_or_b64 vcc, s[52:53], s[72:73]
    s_waitcnt lgkmcnt(0)
    v_cndmask_b32 v216, 0, v216, vcc
    v_cndmask_b32 v217, 0, v217, vcc
    v_cndmask_b32 v218, 0, v218, vcc
    v_cndmask_b32 v219, 0, v219, vcc
    v_cndmask_b32 v220, 0, v220, vcc
    v_cndmask_b32 v221, 0, v221, vcc
    v_cndmask_b32 v222, 0, v222, vcc
    v_cndmask_b32 v223, 0, v223, vcc
    v_lshlrev_b32 v196, 16, v184
    v_and_b32 v197, 0xffff0000, v184
    v_sub_f32 v196, v196, v188
    v_sub_f32 v197, v197, v188
    v_cvt_pk_bf16_f32 v213, v196, v197
    v_lshlrev_b32 v196, 16, v213
    v_and_b32 v197, 0xffff0000, v213
    v_mul_f32 v196, v196, v189
    v_mul_f32 v197, v197, v189
    v_cvt_pk_bf16_f32 v213, v196, v197
    v_lshlrev_b32 v196, 16, v213
    v_and_b32 v197, 0xffff0000, v213
    v_add_f32 v196, v196, v216
    v_add_f32 v197, v197, v217
    v_cvt_pk_bf16_f32 v213, v196, v197
    v_lshlrev_b32 v196, 16, v213
    v_and_b32 v197, 0xffff0000, v213
    v_mul_f32 v213, 0xbfb8aa3b, v196
    v_mul_f32 v214, 0xbfb8aa3b, v197
    v_exp_f32 v213, v213
    v_exp_f32 v214, v214
    v_add_f32 v213, 1.0, v213
    v_add_f32 v214, 1.0, v214
    v_rcp_f32 v213, v213
    v_rcp_f32 v214, v214
    v_mul_f32 v196, v196, v213
    v_mul_f32 v197, v197, v214
    v_cvt_pk_bf16_f32 v213, v196, v197
    v_lshlrev_b32 v196, 16, v213
    v_and_b32 v197, 0xffff0000, v213
    v_lshlrev_b32 v198, 16, v185
    v_and_b32 v199, 0xffff0000, v185
    v_sub_f32 v198, v198, v188
    v_sub_f32 v199, v199, v188
    v_cvt_pk_bf16_f32 v213, v198, v199
    v_lshlrev_b32 v198, 16, v213
    v_and_b32 v199, 0xffff0000, v213
    v_mul_f32 v198, v198, v189
    v_mul_f32 v199, v199, v189
    v_cvt_pk_bf16_f32 v213, v198, v199
    v_lshlrev_b32 v198, 16, v213
    v_and_b32 v199, 0xffff0000, v213
    v_add_f32 v198, v198, v218
    v_add_f32 v199, v199, v219
    v_cvt_pk_bf16_f32 v213, v198, v199
    v_lshlrev_b32 v198, 16, v213
    v_and_b32 v199, 0xffff0000, v213
    v_mul_f32 v213, 0xbfb8aa3b, v198
    v_mul_f32 v214, 0xbfb8aa3b, v199
    v_exp_f32 v213, v213
    v_exp_f32 v214, v214
    v_add_f32 v213, 1.0, v213
    v_add_f32 v214, 1.0, v214
    v_rcp_f32 v213, v213
    v_rcp_f32 v214, v214
    v_mul_f32 v198, v198, v213
    v_mul_f32 v199, v199, v214
    v_cvt_pk_bf16_f32 v213, v198, v199
    v_lshlrev_b32 v198, 16, v213
    v_and_b32 v199, 0xffff0000, v213
    v_lshlrev_b32 v200, 16, v186
    v_and_b32 v201, 0xffff0000, v186
    v_sub_f32 v200, v200, v188
    v_sub_f32 v201, v201, v188
    v_cvt_pk_bf16_f32 v213, v200, v201
    v_lshlrev_b32 v200, 16, v213
    v_and_b32 v201, 0xffff0000, v213
    v_mul_f32 v200, v200, v189
    v_mul_f32 v201, v201, v189
    v_cvt_pk_bf16_f32 v213, v200, v201
    v_lshlrev_b32 v200, 16, v213
    v_and_b32 v201, 0xffff0000, v213
    v_add_f32 v200, v200, v220
    v_add_f32 v201, v201, v221
    v_cvt_pk_bf16_f32 v213, v200, v201
    v_lshlrev_b32 v200, 16, v213
    v_and_b32 v201, 0xffff0000, v213
    v_mul_f32 v213, 0xbfb8aa3b, v200
    v_mul_f32 v214, 0xbfb8aa3b, v201
    v_exp_f32 v213, v213
    v_exp_f32 v214, v214
    v_add_f32 v213, 1.0, v213
    v_add_f32 v214, 1.0, v214
    v_rcp_f32 v213, v213
    v_rcp_f32 v214, v214
    v_mul_f32 v200, v200, v213
    v_mul_f32 v201, v201, v214
    v_cvt_pk_bf16_f32 v213, v200, v201
    v_lshlrev_b32 v200, 16, v213
    v_and_b32 v201, 0xffff0000, v213
    v_lshlrev_b32 v202, 16, v187
    v_and_b32 v203, 0xffff0000, v187
    v_sub_f32 v202, v202, v188
    v_sub_f32 v203, v203, v188
    v_cvt_pk_bf16_f32 v213, v202, v203
    v_lshlrev_b32 v202, 16, v213
    v_and_b32 v203, 0xffff0000, v213
    v_mul_f32 v202, v202, v189
    v_mul_f32 v203, v203, v189
    v_cvt_pk_bf16_f32 v213, v202, v203
    v_lshlrev_b32 v202, 16, v213
    v_and_b32 v203, 0xffff0000, v213
    v_add_f32 v202, v202, v222
    v_add_f32 v203, v203, v223
    v_cvt_pk_bf16_f32 v213, v202, v203
    v_lshlrev_b32 v202, 16, v213
    v_and_b32 v203, 0xffff0000, v213
    v_mul_f32 v213, 0xbfb8aa3b, v202
    v_mul_f32 v214, 0xbfb8aa3b, v203
    v_exp_f32 v213, v213
    v_exp_f32 v214, v214
    v_add_f32 v213, 1.0, v213
    v_add_f32 v214, 1.0, v214
    v_rcp_f32 v213, v213
    v_rcp_f32 v214, v214
    v_mul_f32 v202, v202, v213
    v_mul_f32 v203, v203, v214
    v_cvt_pk_bf16_f32 v213, v202, v203
    v_lshlrev_b32 v202, 16, v213
    v_and_b32 v203, 0xffff0000, v213
    s_branch L_HAVEG
    s_branch BACK_124
RETRY_126:
    s_mov_b32 s58, 200000
RETRYL_127:
    s_add_u32 s42, s41, 0
    buffer_load_dwordx2 v[120:121], v213, s[12:15], s42 offen sc1
    s_add_u32 s42, s41, 3584
    buffer_load_dwordx2 v[122:123], v213, s[12:15], s42 offen sc1
    s_add_u32 s42, s41, 7168
    buffer_load_dwordx2 v[124:125], v213, s[12:15], s42 offen sc1
    s_add_u32 s42, s41, 10752
    buffer_load_dwordx2 v[126:127], v213, s[12:15], s42 offen sc1
    s_add_u32 s42, s41, 14336
    buffer_load_dwordx2 v[128:129], v213, s[12:15], s42 offen sc1
    s_add_u32 s42, s41, 17920
    buffer_load_dwordx2 v[130:131], v213, s[12:15], s42 offen sc1
    s_add_u32 s42, s41, 21504
    buffer_load_dwordx2 v[132:133], v213, s[12:15], s42 offen sc1
    s_add_u32 s42, s41, 25088
    buffer_load_dwordx2 v[134:135], v213, s[12:15], s42 offen sc1
    s_sub_u32 s58, s58, 1
    s_cbranch_scc1 OK_128x
    s_waitcnt vmcnt(0)
    v_cmp_ne_u32 vcc, s36, v121
    v_cmp_ne_u32 s[56:57], s36, v123
    s_nop 0
    s_or_b64 vcc, vcc, s[56:57]
    v_cmp_ne_u32 s[56:57], s36, v125
    s_nop 0
    s_or_b64 vcc, vcc, s[56:57]
    v_cmp_ne_u32 s[56:57], s36, v127
    s_nop 0
    s_or_b64 vcc, vcc, s[56:57]
    v_cmp_ne_u32 s[56:57], s36, v129
    s_nop 0
    s_or_b64 vcc, vcc, s[56:57]
    v_cmp_ne_u32 s[56:57], s36, v131
    s_nop 0
    s_or_b64 vcc, vcc, s[56:57]
    v_cmp_ne_u32 s[56:57], s36, v133
    s_nop 0
    s_or_b64 vcc, vcc, s[56:57]
    v_cmp_ne_u32 s[56:57], s36, v135
    s_nop 0
    s_or_b64 vcc, vcc, s[56:57]
    s_cbranch_vccnz RETRYL_127
OK_128x:
    s_waitcnt vmcnt(0)
    s_branch OK_128
RETRY_130:
    s_mov_b32 s58, 200000
RETRYL_131:
    s_add_u32 s42, s41, 0
    buffer_load_dwordx2 v[120:121], v213, s[12:15], s42 offen sc1
    s_add_u32 s42, s41, 3584
    buffer_load_dwordx2 v[122:123], v213, s[12:15], s42 offen sc1
    s_add_u32 s42, s41, 7168
    buffer_load_dwordx2 v[124:125], v213, s[12:15], s42 offen sc1
    s_add_u32 s42, s41, 10752
    buffer_load_dwordx2 v[126:127], v213, s[12:15], s42 offen sc1
    s_add_u32 s42, s41, 14336
    buffer_load_dwordx2 v[128:129], v213, s[12:15], s42 offen sc1
    s_add_u32 s42, s41, 17920
    buffer_load_dwordx2 v[130:131], v213, s[12:15], s42 offen sc1
    s_add_u32 s42, s41, 21504
    buffer_load_dwordx2 v[132:133], v213, s[12:15], s42 offen sc1
    s_add_u32 s42, s41, 25088
    buffer_load_dwordx2 v[134:135], v213, s[12:15], s42 offen sc1
    s_sub_u32 s58, s58, 1
    s_cbranch_scc1 OK_132x
    s_waitcnt vmcnt(0)
    v_cmp_ne_u32 vcc, s36, v121
    v_cmp_ne_u32 s[56:57], s36, v123
    s_nop 0
    s_or_b64 vcc, vcc, s[56:57]
    v_cmp_ne_u32 s[56:57], s36, v125
    s_nop 0
    s_or_b64 vcc, vcc, s[56:57]
    v_cmp_ne_u32 s[56:57], s36, v127
    s_nop 0
    s_or_b64 vcc, vcc, s[56:57]
    v_cmp_ne_u32 s[56:57], s36, v129
    s_nop 0
    s_or_b64 vcc, vcc, s[56:57]
    v_cmp_ne_u32 s[56:57], s36, v131
    s_nop 0
    s_or_b64 vcc, vcc, s[56:57]
    v_cmp_ne_u32 s[56:57], s36, v133
    s_nop 0
    s_or_b64 vcc, vcc, s[56:57]
    v_cmp_ne_u32 s[56:57], s36, v135
    s_nop 0
    s_or_b64 vcc, vcc, s[56:57]
    s_cbranch_vccnz RETRYL_131
OK_132x:
    s_waitcnt vmcnt(0)
    s_branch OK_132
L_POLL0:
    s_mov_b32 s58, 200000
L_POLL0L:
    s_waitcnt lgkmcnt(0)
    s_xor_b64 vcc, s[92:93], s[36:37]
    s_xor_b64 s[42:43], s[94:95], s[36:37]
    s_or_b64 vcc, vcc, s[42:43]
    s_addc_u32 s33, s33, s33
    s_xor_b64 vcc, s[88:89], s[36:37]
    s_xor_b64 s[42:43], s[90:91], s[36:37]
    s_or_b64 vcc, vcc, s[42:43]
    s_addc_u32 s33, s33, s33
    s_xor_b64 vcc, s[84:85], s[36:37]
    s_xor_b64 s[42:43], s[86:87], s[36:37]
    s_or_b64 vcc, vcc, s[42:43]
    s_addc_u32 s33, s33, s33
    s_xor_b64 vcc, s[80:81], s[36:37]
    s_xor_b64 s[42:43], s[82:83], s[36:37]
    s_or_b64 vcc, vcc, s[42:43]
    s_addc_u32 s33, s33, s33
    s_andn2_b32 s41, s70, s33
    s_cbranch_scc1 L_POLL0D
    s_load_dwordx4 s[80:83], s[76:77], 0 glc
    s_load_dwordx4 s[84:87], s[76:77], 32768 glc
    s_load_dwordx4 s[88:91], s[76:77], 65536 glc
    s_load_dwordx4 s[92:95], s[76:77], 98304 glc
    s_sub_u32 s58, s58, 1
    s_cbranch_scc0 L_POLL0L
    s_waitcnt lgkmcnt(0)
    s_mov_b32 s41, s70
L_POLL0D:
    s_setpc_b64 s[56:57]
L_POLL1:
    s_mov_b32 s58, 200000
L_POLL1L:
    s_waitcnt lgkmcnt(0)
    s_xor_b64 vcc, s[92:93], s[36:37]
    s_xor_b64 s[42:43], s[94:95], s[36:37]
    s_or_b64 vcc, vcc, s[42:43]
    s_addc_u32 s33, s33, s33
    s_xor_b64 vcc, s[88:89], s[36:37]
    s_xor_b64 s[42:43], s[90:91], s[36:37]
    s_or_b64 vcc, vcc, s[42:43]
    s_addc_u32 s33, s33, s33
    s_xor_b64 vcc, s[84:85], s[36:37]
    s_xor_b64 s[42:43], s[86:87], s[36:37]
    s_or_b64 vcc, vcc, s[42:43]
    s_addc_u32 s33, s33, s33
    s_xor_b64 vcc, s[80:81], s[36:37]
    s_xor_b64 s[42:43], s[82:83], s[36:37]
    s_or_b64 vcc, vcc, s[42:43]
    s_addc_u32 s33, s33, s33
    s_andn2_b32 s41, s70, s33
    s_cbranch_scc1 L_POLL1D
    s_load_dwordx4 s[80:83], s[76:77], 4096 glc
    s_load_dwordx4 s[84:87], s[76:77], 36864 glc
    s_load_dwordx4 s[88:91], s[76:77], 69632 glc
    s_load_dwordx4 s[92:95], s[76:77], 102400 glc
    s_sub_u32 s58, s58, 1
    s_cbranch_scc0 L_POLL1L
    s_waitcnt lgkmcnt(0)
    s_mov_b32 s41, s70
L_POLL1D:
    s_setpc_b64 s[56:57]
L_FB:
    s_cmp_lg_u32 s46, 0
    s_cbranch_scc1 L_FBSKIP
    s_mov_b32 s46, 1
    v_mov_b32 v238, 0xff800000
    s_lshl2_add_u32 s43, s47, s48
    s_add_u32 s43, s43, 2
    s_mul_i32 s41, s43, 28672
    s_sub_u32 s41, s59, s41
    s_lshl_b32 s43, s43, 11
    s_sub_u32 s43, s98, s43
    s_mov_b32 s42, 64
FB_133:
    buffer_load_dwordx4 v[152:155], v6, s[12:15], s41 offen offset:0 sc1
    buffer_load_dwordx4 v[156:159], v6, s[12:15], s41 offen offset:1024 sc1
    s_mov_b64 exec, s[52:53]
    buffer_load_dwordx4 v[160:163], v6, s[12:15], s43 offen offset:0 sc1
    buffer_load_dwordx4 v[164:167], v6, s[12:15], s43 offen offset:1024 sc1
    s_mov_b64 exec, -1
    s_waitcnt vmcnt(0)
    v_mfma_f32_32x32x16_bf16 v[104:119], v[152:155], v[32:35], 0
    v_mfma_f32_32x32x16_bf16 v[104:119], v[156:159], v[36:39], v[104:119]
    s_nop 11
    v_max3_f32 v238, v238, v104, v105
    v_max3_f32 v238, v238, v106, v107
    v_max3_f32 v238, v238, v108, v109
    v_max3_f32 v238, v238, v110, v111
    v_max3_f32 v238, v238, v112, v113
    v_max3_f32 v238, v238, v114, v115
    v_max3_f32 v238, v238, v116, v117
    v_max3_f32 v238, v238, v118, v119
    s_add_u32 s41, s41, 28672
    s_add_u32 s43, s43, 2048
    s_sub_u32 s42, s42, 1
    s_cmp_lg_u32 s42, 0
    s_cbranch_scc1 FB_133
    v_mov_b32 v239, v238
    s_nop 1
    v_permlane32_swap_b32 v238, v239
    v_max_f32 v238, v238, v239
    v_mov_b32 v88, 0
    v_mov_b32 v89, 0
    v_mov_b32 v90, 0
    v_mov_b32 v91, 0
    v_mov_b32 v92, 0
    v_mov_b32 v93, 0
    v_mov_b32 v94, 0
    v_mov_b32 v95, 0
    v_mov_b32 v96, 0
    v_mov_b32 v97, 0
    v_mov_b32 v98, 0
    v_mov_b32 v99, 0
    v_mov_b32 v100, 0
    v_mov_b32 v101, 0
    v_mov_b32 v102, 0
    v_mov_b32 v103, 0
    s_lshl2_add_u32 s43, s47, s48
    s_add_u32 s43, s43, 2
    s_mul_i32 s41, s43, 28672
    s_sub_u32 s41, s59, s41
    s_lshl_b32 s43, s43, 11
    s_sub_u32 s43, s98, s43
    s_mov_b32 s42, 64
FB_134:
    buffer_load_dwordx4 v[152:155], v6, s[12:15], s41 offen offset:0 sc1
    buffer_load_dwordx4 v[156:159], v6, s[12:15], s41 offen offset:1024 sc1
    s_mov_b64 exec, s[52:53]
    buffer_load_dwordx4 v[160:163], v6, s[12:15], s43 offen offset:0 sc1
    buffer_load_dwordx4 v[164:167], v6, s[12:15], s43 offen offset:1024 sc1
    s_mov_b64 exec, -1
    s_waitcnt vmcnt(0)
    v_mfma_f32_32x32x16_bf16 v[104:119], v[152:155], v[32:35], 0
    v_mfma_f32_32x32x16_bf16 v[104:119], v[156:159], v[36:39], v[104:119]
    s_nop 11
    v_sub_f32 v104, v104, v238
    v_exp_f32 v104, v104
    v_sub_f32 v105, v105, v238
    v_exp_f32 v105, v105
    v_sub_f32 v106, v106, v238
    v_exp_f32 v106, v106
    v_sub_f32 v107, v107, v238
    v_exp_f32 v107, v107
    v_sub_f32 v108, v108, v238
    v_exp_f32 v108, v108
    v_sub_f32 v109, v109, v238
    v_exp_f32 v109, v109
    v_sub_f32 v110, v110, v238
    v_exp_f32 v110, v110
    v_sub_f32 v111, v111, v238
    v_exp_f32 v111, v111
    v_sub_f32 v112, v112, v238
    v_exp_f32 v112, v112
    v_sub_f32 v113, v113, v238
    v_exp_f32 v113, v113
    v_sub_f32 v114, v114, v238
    v_exp_f32 v114, v114
    v_sub_f32 v115, v115, v238
    v_exp_f32 v115, v115
    v_sub_f32 v116, v116, v238
    v_exp_f32 v116, v116
    v_sub_f32 v117, v117, v238
    v_exp_f32 v117, v117
    v_sub_f32 v118, v118, v238
    v_exp_f32 v118, v118
    v_sub_f32 v119, v119, v238
    v_exp_f32 v119, v119
    v_smfmac_f32_32x32x32_bf16 v[88:103], v[160:163], v[104:111], v2
    s_nop 0
    v_smfmac_f32_32x32x32_bf16 v[88:103], v[164:167], v[112:119], v2
    s_nop 15
    s_add_u32 s41, s41, 28672
    s_add_u32 s43, s43, 2048
    s_sub_u32 s42, s42, 1
    s_cmp_lg_u32 s42, 0
    s_cbranch_scc1 FB_134
    v_mov_b32 v234, v100
    v_mov_b32 v235, v100
    s_branch L_FBRET
L_END:
    s_endpgm
.section .rodata,"a"
.p2align 6
.amdhsa_kernel recurrent_scan__mha_block__moe_arch_mod__prompt_kernel
  .amdhsa_next_free_vgpr 256
  .amdhsa_next_free_sgpr 102
  .amdhsa_accum_offset 256
  .amdhsa_group_segment_fixed_size 0
  .amdhsa_kernarg_size 88
  .amdhsa_user_sgpr_count 2
  .amdhsa_user_sgpr_kernarg_segment_ptr 1
  .amdhsa_system_sgpr_workgroup_id_x 1
.end_amdhsa_kernel
```
